```python
import torch

def _softmax(x, axis=-1):
    return torch.softmax(x, dim=axis)
def _gelu(x):
    return torch.nn.functional.gelu(x, approximate="tanh")
def _silu(x):
    return torch.nn.functional.silu(x)
def _sigmoid(x):
    return torch.sigmoid(x)
def _layernorm(x, axis=-1, eps=1e-5):
    m = x.mean(dim=axis, keepdim=True)
    v = x.var(dim=axis, keepdim=True, unbiased=False)
    return (x - m) / torch.sqrt(v + eps)
def _scatter_add(tgt, idx, src, axis=0):
    return tgt.clone().index_add_(axis, idx, src)
def _segment_sum(src, seg, n):
    out = torch.zeros((n,) + src.shape[1:], dtype=src.dtype)
    return out.index_add_(0, seg, src)
def _pad(x, pw):
    flat = tuple(v for pair in reversed(pw) for v in pair)
    return torch.nn.functional.pad(x, flat)

kernel_name = 'recurrent_scan__sliding_block_cached__mixer_token_mlp__decode'

def setup_inputs():

    _w = (lambda a: (lambda t: t.to(torch.bfloat16) if t.is_floating_point() else t)(torch.as_tensor(a)))
    def _A_setup():
        B, Sq, D = 1, 1, 1024
        Hq, Hkv, Sk, Dh = 32, 4, 65536, 128
        assert Hq % Hkv == 0, (Hq, Hkv)
        return {
            "x": _w((lambda *s: torch.randn(*s, dtype=torch.bfloat16) * 0.05)(B, Sq, D)),
            "k_cache": _w((lambda *s: torch.randn(*s, dtype=torch.bfloat16) * 1.6)(B, Hkv, Sk, Dh)),
            "v_cache": _w((lambda *s: torch.randn(*s, dtype=torch.bfloat16) * 1.6)(B, Hkv, Sk, Dh)),
            "wq": _w((lambda *s: torch.randn(*s, dtype=torch.bfloat16) * 1.6)(D, Hq * Dh) * (D ** -0.5)),
            "wo": _w((lambda *s: torch.randn(*s, dtype=torch.bfloat16) * 1.6)(Hq * Dh, D) * ((Hq * Dh) ** -0.5)),
        }
    _A_in = _A_setup()

    def _B_setup():
        B, S, D, F = 1, 1, 1024, 3584
        return {
            "x": _w((lambda *s: torch.randn(*s, dtype=torch.bfloat16) * 0.05)(B, S, D)),
            "w1": _w((lambda *s: torch.randn(*s, dtype=torch.bfloat16) * 0.2)(S, F) * (S ** -0.5)),
            "b1": _w((lambda *s: torch.randn(*s, dtype=torch.bfloat16) * 0.2)(F) * 0.02),
            "w2": _w((lambda *s: torch.randn(*s, dtype=torch.bfloat16) * 0.2)(F, S) * (F ** -0.5)),
            "b2": _w((lambda *s: torch.randn(*s, dtype=torch.bfloat16) * 0.2)(S) * 0.02),
        }
    _B_in = _B_setup()

    return {
        "A_x": _A_in["x"],
        "A_k_cache": _A_in["k_cache"],
        "A_v_cache": _A_in["v_cache"],
        "A_wq": _A_in["wq"],
        "A_wo": _A_in["wo"],
        "B_x": _B_in["x"],
        "B_w1": _B_in["w1"],
        "B_b1": _B_in["b1"],
        "B_w2": _B_in["w2"],
        "B_b2": _B_in["b2"],
    }

def reference(A_x, A_k_cache, A_v_cache, A_wq, A_wo, B_x, B_w1, B_b1, B_w2, B_b2):
    def _A_ref(x, k_cache, v_cache, wq, wo):
        B, Sq, D = x.shape
        Hq, Dh = 32, 128
        Hkv, Sk = k_cache.shape[1], k_cache.shape[2]
        W = min(4096, max(256, Sk // 4))
        rep = Hq // Hkv
        q = (lambda x, *d: x.permute(*d))((x @ wq).reshape(B, Sq, Hq, Dh), 0, 2, 1, 3)
        k = (lambda x, n, axis: torch.repeat_interleave(x, n, dim=axis))(k_cache[:, :, Sk - W:, :], rep, axis=1)
        v = (lambda x, n, axis: torch.repeat_interleave(x, n, dim=axis))(v_cache[:, :, Sk - W:, :], rep, axis=1)
        scores = torch.einsum("bhqd,bhkd->bhqk", q, k) * (Dh ** -0.5)
        p = _softmax(scores, axis=-1)
        o = torch.einsum("bhqk,bhkd->bhqd", p, v)
        return (lambda x, *d: x.permute(*d))(o, 0, 2, 1, 3).reshape(B, Sq, Hq * Dh) @ wo

    def _B_ref(x, w1, b1, w2, b2):
        B, S, D = x.shape
        h = _layernorm(x, axis=-1)
        u = torch.einsum("bsd,sf->bdf", h, w1) + b1
        u = _gelu(u)
        y = torch.einsum("bdf,fs->bds", u, w2) + b2
        return (lambda x, *d: x.permute(*d))(y, 0, 2, 1)

    x = A_x
    xn = _layernorm(x, axis=-1)
    s = _A_ref(xn, A_k_cache, A_v_cache, A_wq, A_wo)
    g = _silu(_B_ref(xn, B_w1, B_b1, B_w2, B_b2))
    return x + s * g
```

```asm
; @launch grid=(256,1,1) block=(512,1,1) lds=145872
.amdgcn_target "amdgcn-amd-amdhsa--gfx950"
.text
.globl recurrent_scan__sliding_block_cached__mixer_token_mlp__decode_kernel
.p2align 12
.fill 832, 4, 0xbf810000
.p2align 8
.type recurrent_scan__sliding_block_cached__mixer_token_mlp__decode_kernel,@function
recurrent_scan__sliding_block_cached__mixer_token_mlp__decode_kernel:
    s_cmp_ge_u32 s2, 256
    s_cbranch_scc1 L_exit
    s_load_dwordx16 s[4:19], s[0:1], 0
    s_load_dwordx4 s[20:23], s[0:1], 64
    s_load_dwordx2 s[24:25], s[0:1], 80
    s_load_dwordx2 s[26:27], s[0:1], 96
    v_lshrrev_b32 v1, 6, v0
    v_and_b32 v0, 63, v0
    s_and_b32 s48, s2, 7
    v_readfirstlane_b32 s3, v1
    s_lshr_b32 s49, s2, 3
    s_lshl_b32 s46, s48, 3
    s_and_b32 s47, s49, 7
    s_add_u32 s46, s46, s47
    s_lshr_b32 s47, s49, 3
    s_cmp_eq_u32 s3, 0
    s_cbranch_scc0 L_not0
    v_lshrrev_b32 v24, 3, v0
    v_and_b32 v25, 7, v0
    v_lshlrev_b32 v25, 4, v25
    v_bfe_u32 v27, v24, 1, 2
    v_lshlrev_b32 v27, 5, v27
    v_xor_b32 v25, v25, v27
    v_lshl_add_u32 v24, v24, 13, v25
    s_lshl_b32 s56, s47, 21
    s_lshl_b32 s57, s46, 7
    s_add_u32 s56, s56, s57
    s_mov_b32 m0, 0
    s_mov_b32 s57, 0
    s_mov_b32 s38, 8388608
    s_mov_b32 s39, 0x20000
    s_waitcnt lgkmcnt(0)
    s_mov_b32 s36, s10
    s_and_b32 s37, s11, 0xffff
L_wqloop:
    buffer_load_dwordx4 v24, s[36:39], s56 offen nt lds
    s_add_u32 m0, m0, 1024
    s_add_u32 s56, s56, 65536
    buffer_load_dwordx4 v24, s[36:39], s56 offen nt lds
    s_add_u32 m0, m0, 1024
    s_add_u32 s56, s56, 65536
    buffer_load_dwordx4 v24, s[36:39], s56 offen nt lds
    s_add_u32 m0, m0, 1024
    s_add_u32 s56, s56, 65536
    buffer_load_dwordx4 v24, s[36:39], s56 offen nt lds
    s_add_u32 m0, m0, 1024
    s_add_u32 s56, s56, 65536
    s_add_u32 s57, s57, 4
    s_cmp_lt_u32 s57, 32
    s_cbranch_scc1 L_wqloop
    v_lshrrev_b32 v2, 4, v0
    v_and_b32 v3, 15, v0
    s_mov_b32 s51, 1048576
    v_mov_b32 v21, 143488
    v_mov_b32 v22, 1
    s_mov_b32 s98, 0
    s_barrier
    s_branch L_qproj
L_not0:
    v_lshrrev_b32 v2, 4, v0
    v_and_b32 v3, 15, v0
    s_mov_b32 s51, 1048576
    v_mov_b32 v21, 143488
    v_mov_b32 v22, 1
    s_mov_b32 s98, 0
    s_cmp_eq_u32 s3, 1
    s_cbranch_scc0 L_not1
    v_lshlrev_b32 v23, 5, v0
    v_mov_b32 v24, 0
    s_waitcnt lgkmcnt(0)
    s_mov_b32 s28, s26
    s_and_b32 s29, s27, 0xffff
    s_mov_b32 s30, 268435456
    s_mov_b32 s31, 0x20000
    s_mov_b32 s32, s4
    s_and_b32 s33, s5, 0xffff
    s_mov_b32 s34, 2048
    s_mov_b32 s35, 0x20000
    buffer_load_dwordx4 v[4:7], v23, s[32:35], 0 offen
    buffer_load_dwordx4 v[8:11], v23, s[32:35], 0 offen offset:16
    buffer_load_dword v20, v24, s[28:31], 0 offen sc1
    s_barrier
    s_branch L_ln
L_not1:
    s_cmp_ge_u32 s3, 6
    s_cbranch_scc1 L_bearly
    s_cmp_ge_u32 s3, 4
    s_cbranch_scc1 L_learly
    s_cmp_eq_u32 s3, 2
    s_cbranch_scc0 L_cpf_1
    s_getpc_b64 s[54:55]
L_pc:
    s_sub_u32 s54, s54, L_pc-recurrent_scan__sliding_block_cached__mixer_token_mlp__decode_kernel
    s_subb_u32 s55, s55, 0
    s_mul_i32 s56, s49, 6
    v_add_u32 v24, s56, v0
    v_lshlrev_b32 v24, 7, v24
    s_mov_b32 s56, L_exit-recurrent_scan__sliding_block_cached__mixer_token_mlp__decode_kernel
    v_cmp_gt_u32 vcc, s56, v24
    s_and_b64 exec, vcc, 0x3f
    s_cbranch_execz L_cpf_2
    global_load_dword v150, v24, s[54:55]
L_cpf_2:
    s_mov_b64 exec, -1
L_cpf_1:
    s_barrier
    s_branch L_w23
L_learly:
    s_cmp_eq_u32 s3, 4
    s_cbranch_scc0 L_nz_3
    v_lshlrev_b32 v4, 2, v0
    v_add_u32 v4, 143488, v4
    v_mov_b32 v5, 0
    s_mov_b64 exec, 0xffffffff
    ds_write_b32 v4, v5
    s_mov_b64 exec, -1
    s_waitcnt lgkmcnt(0)
L_nz_3:
    s_barrier
    s_branch L_loader
L_bearly:
    s_sub_u32 s52, s3, 6
    s_lshr_b32 s53, s2, 4
    s_and_b32 s54, s2, 15
    v_and_b32 v23, 31, v0
    v_lshlrev_b32 v23, 1, v23
    s_lshl_b32 s55, s53, 7
    s_lshl_b32 s56, s52, 6
    s_add_u32 s55, s55, s56
    s_mul_i32 s56, s54, 448
    v_lshlrev_b32 v24, 1, v0
    s_waitcnt lgkmcnt(0)
    s_mov_b32 s28, s26
    s_and_b32 s29, s27, 0xffff
    s_mov_b32 s30, 268435456
    s_mov_b32 s31, 0x20000
    s_mov_b32 s32, s4
    s_and_b32 s33, s5, 0xffff
    s_mov_b32 s34, 2048
    s_mov_b32 s35, 0x20000
    s_mov_b32 s36, s16
    s_and_b32 s37, s17, 0xffff
    s_mov_b32 s38, 7168
    s_mov_b32 s39, 0x20000
    s_mov_b32 s40, s18
    s_and_b32 s41, s19, 0xffff
    s_mov_b32 s42, 7168
    s_mov_b32 s43, 0x20000
    s_mov_b32 s44, s20
    s_and_b32 s45, s21, 0xffff
    s_mov_b32 s46, 7168
    s_mov_b32 s47, 0x20000
    buffer_load_ushort v12, v23, s[32:35], s55 offen
    buffer_load_ushort v40, v24, s[36:39], s56 offen offset:0
    buffer_load_ushort v41, v24, s[40:43], s56 offen offset:0
    buffer_load_ushort v48, v24, s[44:47], s56 offen offset:0
    buffer_load_ushort v42, v24, s[36:39], s56 offen offset:128
    buffer_load_ushort v43, v24, s[40:43], s56 offen offset:128
    buffer_load_ushort v50, v24, s[44:47], s56 offen offset:128
    buffer_load_ushort v44, v24, s[36:39], s56 offen offset:256
    buffer_load_ushort v45, v24, s[40:43], s56 offen offset:256
    buffer_load_ushort v52, v24, s[44:47], s56 offen offset:256
    buffer_load_ushort v46, v24, s[36:39], s56 offen offset:384
    buffer_load_ushort v47, v24, s[40:43], s56 offen offset:384
    buffer_load_ushort v54, v24, s[44:47], s56 offen offset:384
    s_load_dword s59, s[22:23], 0
    s_barrier
    s_branch L_bbranch
L_ln:
    s_setprio 3
    s_lshl_b32 s54, s47, 4
    v_subrev_u32 v23, s54, v0
    v_lshlrev_b32 v23, 5, v23
    v_add_u32 v23, 144704, v23
    s_mov_b32 s56, 0xffff
    s_mov_b32 s57, 0
    s_lshl_b64 s[58:59], s[56:57], s54
    s_waitcnt vmcnt(0)
    v_readfirstlane_b32 s50, v20
    v_lshlrev_b32 v24, 16, v4
    v_and_b32 v25, 0xffff0000, v4
    v_lshlrev_b32 v26, 16, v5
    v_and_b32 v27, 0xffff0000, v5
    v_lshlrev_b32 v28, 16, v6
    v_and_b32 v29, 0xffff0000, v6
    v_lshlrev_b32 v30, 16, v7
    v_and_b32 v31, 0xffff0000, v7
    v_lshlrev_b32 v32, 16, v8
    v_and_b32 v33, 0xffff0000, v8
    v_lshlrev_b32 v34, 16, v9
    v_and_b32 v35, 0xffff0000, v9
    v_lshlrev_b32 v36, 16, v10
    v_and_b32 v37, 0xffff0000, v10
    v_lshlrev_b32 v38, 16, v11
    v_and_b32 v39, 0xffff0000, v11
    s_add_u32 s50, s50, 1
    s_mul_i32 s50, s50, 0x9e3779b1
    v_add_f32 v98, v24, v25
    v_add_f32 v99, v26, v27
    v_add_f32 v98, v98, v28
    v_add_f32 v99, v99, v29
    v_add_f32 v98, v98, v30
    v_add_f32 v99, v99, v31
    v_add_f32 v98, v98, v32
    v_add_f32 v99, v99, v33
    v_add_f32 v98, v98, v34
    v_add_f32 v99, v99, v35
    v_add_f32 v98, v98, v36
    v_add_f32 v99, v99, v37
    v_add_f32 v98, v98, v38
    v_add_f32 v99, v99, v39
    v_add_f32 v98, v98, v99
    s_nop 1
    v_add_f32_dpp v98, v98, v98 row_ror:8 row_mask:0xf bank_mask:0xf
    s_nop 1
    v_add_f32_dpp v98, v98, v98 row_ror:4 row_mask:0xf bank_mask:0xf
    s_nop 1
    v_add_f32_dpp v98, v98, v98 row_ror:2 row_mask:0xf bank_mask:0xf
    s_nop 1
    v_add_f32_dpp v98, v98, v98 row_ror:1 row_mask:0xf bank_mask:0xf
    v_mov_b32 v99, v98
    s_nop 1
    v_permlane32_swap_b32 v98, v99
    v_add_f32 v98, v98, v99
    v_mov_b32 v99, v98
    s_nop 1
    v_permlane16_swap_b32 v98, v99
    v_add_f32 v98, v98, v99
    v_mul_f32 v98, 0x3a800000, v98
    v_sub_f32 v99, v24, v98
    v_sub_f32 v101, v25, v98
    v_mul_f32 v100, v99, v99
    v_mul_f32 v102, v101, v101
    v_sub_f32 v99, v26, v98
    v_sub_f32 v101, v27, v98
    v_fmac_f32 v100, v99, v99
    v_fmac_f32 v102, v101, v101
    v_sub_f32 v99, v28, v98
    v_sub_f32 v101, v29, v98
    v_fmac_f32 v100, v99, v99
    v_fmac_f32 v102, v101, v101
    v_sub_f32 v99, v30, v98
    v_sub_f32 v101, v31, v98
    v_fmac_f32 v100, v99, v99
    v_fmac_f32 v102, v101, v101
    v_sub_f32 v99, v32, v98
    v_sub_f32 v101, v33, v98
    v_fmac_f32 v100, v99, v99
    v_fmac_f32 v102, v101, v101
    v_sub_f32 v99, v34, v98
    v_sub_f32 v101, v35, v98
    v_fmac_f32 v100, v99, v99
    v_fmac_f32 v102, v101, v101
    v_sub_f32 v99, v36, v98
    v_sub_f32 v101, v37, v98
    v_fmac_f32 v100, v99, v99
    v_fmac_f32 v102, v101, v101
    v_sub_f32 v99, v38, v98
    v_sub_f32 v101, v39, v98
    v_fmac_f32 v100, v99, v99
    v_fmac_f32 v102, v101, v101
    v_add_f32 v100, v100, v102
    s_nop 1
    v_add_f32_dpp v100, v100, v100 row_ror:8 row_mask:0xf bank_mask:0xf
    s_nop 1
    v_add_f32_dpp v100, v100, v100 row_ror:4 row_mask:0xf bank_mask:0xf
    s_nop 1
    v_add_f32_dpp v100, v100, v100 row_ror:2 row_mask:0xf bank_mask:0xf
    s_nop 1
    v_add_f32_dpp v100, v100, v100 row_ror:1 row_mask:0xf bank_mask:0xf
    v_mov_b32 v99, v100
    s_nop 1
    v_permlane32_swap_b32 v100, v99
    v_add_f32 v100, v100, v99
    v_mov_b32 v99, v100
    s_nop 1
    v_permlane16_swap_b32 v100, v99
    v_add_f32 v100, v100, v99
    v_mul_f32 v100, 0x3a800000, v100
    v_cvt_pk_bf16_f32 v104, v98, v98
    v_lshlrev_b32 v104, 16, v104
    v_cvt_pk_bf16_f32 v99, v100, v100
    v_lshlrev_b32 v99, 16, v99
    v_add_f32 v99, 0x3727c5ac, v99
    v_cvt_pk_bf16_f32 v99, v99, v99
    v_lshlrev_b32 v99, 16, v99
    v_sqrt_f32 v99, v99
    s_nop 0
    v_cvt_pk_bf16_f32 v99, v99, v99
    v_lshlrev_b32 v99, 16, v99
    v_rcp_f32 v105, v99
    s_nop 0
    v_mov_b32 v20, s50
    ds_write_b32 v21, v20 offset:100
    v_sub_f32 v24, v24, v104
    v_sub_f32 v25, v25, v104
    v_sub_f32 v26, v26, v104
    v_sub_f32 v27, v27, v104
    v_sub_f32 v28, v28, v104
    v_sub_f32 v29, v29, v104
    v_sub_f32 v30, v30, v104
    v_sub_f32 v31, v31, v104
    v_sub_f32 v32, v32, v104
    v_sub_f32 v33, v33, v104
    v_sub_f32 v34, v34, v104
    v_sub_f32 v35, v35, v104
    v_sub_f32 v36, v36, v104
    v_sub_f32 v37, v37, v104
    v_sub_f32 v38, v38, v104
    v_sub_f32 v39, v39, v104
    v_cvt_pk_bf16_f32 v4, v24, v25
    v_cvt_pk_bf16_f32 v5, v26, v27
    v_cvt_pk_bf16_f32 v6, v28, v29
    v_cvt_pk_bf16_f32 v7, v30, v31
    v_cvt_pk_bf16_f32 v8, v32, v33
    v_cvt_pk_bf16_f32 v9, v34, v35
    v_cvt_pk_bf16_f32 v10, v36, v37
    v_cvt_pk_bf16_f32 v11, v38, v39
    v_lshlrev_b32 v24, 16, v4
    v_and_b32 v25, 0xffff0000, v4
    v_lshlrev_b32 v26, 16, v5
    v_and_b32 v27, 0xffff0000, v5
    v_lshlrev_b32 v28, 16, v6
    v_and_b32 v29, 0xffff0000, v6
    v_lshlrev_b32 v30, 16, v7
    v_and_b32 v31, 0xffff0000, v7
    v_lshlrev_b32 v32, 16, v8
    v_and_b32 v33, 0xffff0000, v8
    v_lshlrev_b32 v34, 16, v9
    v_and_b32 v35, 0xffff0000, v9
    v_lshlrev_b32 v36, 16, v10
    v_and_b32 v37, 0xffff0000, v10
    v_lshlrev_b32 v38, 16, v11
    v_and_b32 v39, 0xffff0000, v11
    v_mul_f32 v24, v24, v105
    v_mul_f32 v25, v25, v105
    v_mul_f32 v26, v26, v105
    v_mul_f32 v27, v27, v105
    v_mul_f32 v28, v28, v105
    v_mul_f32 v29, v29, v105
    v_mul_f32 v30, v30, v105
    v_mul_f32 v31, v31, v105
    v_mul_f32 v32, v32, v105
    v_mul_f32 v33, v33, v105
    v_mul_f32 v34, v34, v105
    v_mul_f32 v35, v35, v105
    v_mul_f32 v36, v36, v105
    v_mul_f32 v37, v37, v105
    v_mul_f32 v38, v38, v105
    v_mul_f32 v39, v39, v105
    v_cvt_pk_bf16_f32 v4, v24, v25
    v_cvt_pk_bf16_f32 v5, v26, v27
    v_cvt_pk_bf16_f32 v6, v28, v29
    v_cvt_pk_bf16_f32 v7, v30, v31
    v_cvt_pk_bf16_f32 v8, v32, v33
    v_cvt_pk_bf16_f32 v9, v34, v35
    v_cvt_pk_bf16_f32 v10, v36, v37
    v_cvt_pk_bf16_f32 v11, v38, v39
    s_mov_b64 exec, s[58:59]
    ds_write_b128 v23, v[4:7]
    ds_write_b128 v23, v[8:11] offset:16
    s_mov_b64 exec, -1
    ds_write_b32 v21, v22 offset:92
    v_lshlrev_b32 v24, 16, v4
    v_and_b32 v25, 0xffff0000, v4
    v_lshlrev_b32 v26, 16, v5
    v_and_b32 v27, 0xffff0000, v5
    v_lshlrev_b32 v28, 16, v6
    v_and_b32 v29, 0xffff0000, v6
    v_lshlrev_b32 v30, 16, v7
    v_and_b32 v31, 0xffff0000, v7
    v_lshlrev_b32 v32, 16, v8
    v_and_b32 v33, 0xffff0000, v8
    v_lshlrev_b32 v34, 16, v9
    v_and_b32 v35, 0xffff0000, v9
    v_lshlrev_b32 v36, 16, v10
    v_and_b32 v37, 0xffff0000, v10
    v_lshlrev_b32 v38, 16, v11
    v_and_b32 v39, 0xffff0000, v11
    v_add_f32 v98, v24, v25
    v_add_f32 v99, v26, v27
    v_add_f32 v98, v98, v28
    v_add_f32 v99, v99, v29
    v_add_f32 v98, v98, v30
    v_add_f32 v99, v99, v31
    v_add_f32 v98, v98, v32
    v_add_f32 v99, v99, v33
    v_add_f32 v98, v98, v34
    v_add_f32 v99, v99, v35
    v_add_f32 v98, v98, v36
    v_add_f32 v99, v99, v37
    v_add_f32 v98, v98, v38
    v_add_f32 v99, v99, v39
    v_add_f32 v98, v98, v99
    s_nop 1
    v_add_f32_dpp v98, v98, v98 row_ror:8 row_mask:0xf bank_mask:0xf
    s_nop 1
    v_add_f32_dpp v98, v98, v98 row_ror:4 row_mask:0xf bank_mask:0xf
    s_nop 1
    v_add_f32_dpp v98, v98, v98 row_ror:2 row_mask:0xf bank_mask:0xf
    s_nop 1
    v_add_f32_dpp v98, v98, v98 row_ror:1 row_mask:0xf bank_mask:0xf
    v_mov_b32 v99, v98
    s_nop 1
    v_permlane32_swap_b32 v98, v99
    v_add_f32 v98, v98, v99
    v_mov_b32 v99, v98
    s_nop 1
    v_permlane16_swap_b32 v98, v99
    v_add_f32 v98, v98, v99
    v_mul_f32 v98, 0x3a800000, v98
    v_sub_f32 v99, v24, v98
    v_sub_f32 v101, v25, v98
    v_mul_f32 v100, v99, v99
    v_mul_f32 v102, v101, v101
    v_sub_f32 v99, v26, v98
    v_sub_f32 v101, v27, v98
    v_fmac_f32 v100, v99, v99
    v_fmac_f32 v102, v101, v101
    v_sub_f32 v99, v28, v98
    v_sub_f32 v101, v29, v98
    v_fmac_f32 v100, v99, v99
    v_fmac_f32 v102, v101, v101
    v_sub_f32 v99, v30, v98
    v_sub_f32 v101, v31, v98
    v_fmac_f32 v100, v99, v99
    v_fmac_f32 v102, v101, v101
    v_sub_f32 v99, v32, v98
    v_sub_f32 v101, v33, v98
    v_fmac_f32 v100, v99, v99
    v_fmac_f32 v102, v101, v101
    v_sub_f32 v99, v34, v98
    v_sub_f32 v101, v35, v98
    v_fmac_f32 v100, v99, v99
    v_fmac_f32 v102, v101, v101
    v_sub_f32 v99, v36, v98
    v_sub_f32 v101, v37, v98
    v_fmac_f32 v100, v99, v99
    v_fmac_f32 v102, v101, v101
    v_sub_f32 v99, v38, v98
    v_sub_f32 v101, v39, v98
    v_fmac_f32 v100, v99, v99
    v_fmac_f32 v102, v101, v101
    v_add_f32 v100, v100, v102
    s_nop 1
    v_add_f32_dpp v100, v100, v100 row_ror:8 row_mask:0xf bank_mask:0xf
    s_nop 1
    v_add_f32_dpp v100, v100, v100 row_ror:4 row_mask:0xf bank_mask:0xf
    s_nop 1
    v_add_f32_dpp v100, v100, v100 row_ror:2 row_mask:0xf bank_mask:0xf
    s_nop 1
    v_add_f32_dpp v100, v100, v100 row_ror:1 row_mask:0xf bank_mask:0xf
    v_mov_b32 v99, v100
    s_nop 1
    v_permlane32_swap_b32 v100, v99
    v_add_f32 v100, v100, v99
    v_mov_b32 v99, v100
    s_nop 1
    v_permlane16_swap_b32 v100, v99
    v_add_f32 v100, v100, v99
    v_mul_f32 v100, 0x3a800000, v100
    v_cvt_pk_bf16_f32 v106, v98, v98
    v_lshlrev_b32 v106, 16, v106
    v_cvt_pk_bf16_f32 v99, v100, v100
    v_lshlrev_b32 v99, 16, v99
    v_add_f32 v99, 0x3727c5ac, v99
    v_cvt_pk_bf16_f32 v99, v99, v99
    v_lshlrev_b32 v99, 16, v99
    v_sqrt_f32 v99, v99
    s_nop 0
    v_cvt_pk_bf16_f32 v99, v99, v99
    v_lshlrev_b32 v99, 16, v99
    v_rcp_f32 v107, v99
    s_nop 0
    v_mov_b32 v23, 145216
    ds_write_b128 v23, v[104:107]
    ds_write_b32 v21, v22 offset:96
    s_branch L_prep
L_qproj:
    s_setprio 3
    s_mov_b32 s28, s26
    s_and_b32 s29, s27, 0xffff
    s_mov_b32 s30, 268435456
    s_mov_b32 s31, 0x20000
    s_branch L_prep
L_qproj2:
    v_lshrrev_b32 v24, 2, v3
    v_and_b32 v25, 3, v3
    v_lshlrev_b32 v26, 2, v2
    v_add_u32 v26, v26, v24
    v_lshrrev_b32 v27, 1, v26
    v_and_b32 v27, 3, v27
    v_lshlrev_b32 v26, 7, v26
    v_lshlrev_b32 v25, 3, v25
    v_add_u32 v26, v26, v25
    v_lshlrev_b32 v27, 5, v27
    v_add_u32 v108, v26, v27
    v_xor_b32 v109, 32, v108
    v_xor_b32 v110, 64, v108
    v_xor_b32 v111, 96, v108
    s_lshr_b32 s57, s46, 1
    s_lshl_b32 s57, s57, 11
    s_and_b32 s58, s46, 1
    s_lshl_b32 s58, s58, 8
    s_add_u32 s57, s57, s58
    s_lshl_b32 s58, s47, 9
    s_add_u32 s57, s57, s58
    s_add_u32 s46, s57, 65536
    s_add_u32 s47, s57, 131072
    v_lshlrev_b32 v27, 2, v0
    v_lshlrev_b32 v26, 3, v2
    v_add_u32 v26, 144704, v26
L_wf_4:
    ds_read_b32 v28, v21 offset:92
    ds_read_b32 v29, v21 offset:100
    ds_read2_b64 v[40:43], v26 offset0:0 offset1:4
    ds_read2_b64 v[44:47], v26 offset0:8 offset1:12
    ds_read2_b64 v[48:51], v26 offset0:16 offset1:20
    ds_read2_b64 v[52:55], v26 offset0:24 offset1:28
    ds_read2_b64 v[56:59], v26 offset0:32 offset1:36
    ds_read2_b64 v[60:63], v26 offset0:40 offset1:44
    ds_read2_b64 v[64:67], v26 offset0:48 offset1:52
    ds_read2_b64 v[68:71], v26 offset0:56 offset1:60
    s_sub_u32 s51, s51, 1
    s_cbranch_scc1 L_abort
    s_waitcnt lgkmcnt(0)
    v_cmp_ne_u32 vcc, 0, v28
    s_cbranch_vccz L_wf_4
    v_readfirstlane_b32 s50, v29
    s_mov_b32 s58, 0x3e0293ee
    s_waitcnt vmcnt(28)
    ds_read_b64_tr_b16 v[128:129], v108 offset:0
    ds_read_b64_tr_b16 v[130:131], v108 offset:2048
    ds_read_b64_tr_b16 v[132:133], v109 offset:0
    ds_read_b64_tr_b16 v[134:135], v109 offset:2048
    ds_read_b64_tr_b16 v[136:137], v110 offset:0
    ds_read_b64_tr_b16 v[138:139], v110 offset:2048
    ds_read_b64_tr_b16 v[140:141], v111 offset:0
    ds_read_b64_tr_b16 v[142:143], v111 offset:2048
    s_waitcnt vmcnt(24)
    ds_read_b64_tr_b16 v[144:145], v108 offset:4096
    ds_read_b64_tr_b16 v[146:147], v108 offset:6144
    ds_read_b64_tr_b16 v[148:149], v109 offset:4096
    ds_read_b64_tr_b16 v[150:151], v109 offset:6144
    ds_read_b64_tr_b16 v[152:153], v110 offset:4096
    ds_read_b64_tr_b16 v[154:155], v110 offset:6144
    ds_read_b64_tr_b16 v[156:157], v111 offset:4096
    ds_read_b64_tr_b16 v[158:159], v111 offset:6144
    s_waitcnt lgkmcnt(8)
    v_mfma_f32_16x16x32_bf16 v[72:75], v[40:43], v[128:131], 0
    v_mfma_f32_16x16x32_bf16 v[76:79], v[40:43], v[132:135], 0
    v_mfma_f32_16x16x32_bf16 v[80:83], v[40:43], v[136:139], 0
    v_mfma_f32_16x16x32_bf16 v[84:87], v[40:43], v[140:143], 0
    s_waitcnt vmcnt(20)
    ds_read_b64_tr_b16 v[128:129], v108 offset:8192
    ds_read_b64_tr_b16 v[130:131], v108 offset:10240
    ds_read_b64_tr_b16 v[132:133], v109 offset:8192
    ds_read_b64_tr_b16 v[134:135], v109 offset:10240
    ds_read_b64_tr_b16 v[136:137], v110 offset:8192
    ds_read_b64_tr_b16 v[138:139], v110 offset:10240
    ds_read_b64_tr_b16 v[140:141], v111 offset:8192
    ds_read_b64_tr_b16 v[142:143], v111 offset:10240
    s_waitcnt lgkmcnt(8)
    v_mfma_f32_16x16x32_bf16 v[72:75], v[44:47], v[144:147], v[72:75]
    v_mfma_f32_16x16x32_bf16 v[76:79], v[44:47], v[148:151], v[76:79]
    v_mfma_f32_16x16x32_bf16 v[80:83], v[44:47], v[152:155], v[80:83]
    v_mfma_f32_16x16x32_bf16 v[84:87], v[44:47], v[156:159], v[84:87]
    s_waitcnt vmcnt(16)
    ds_read_b64_tr_b16 v[144:145], v108 offset:12288
    ds_read_b64_tr_b16 v[146:147], v108 offset:14336
    ds_read_b64_tr_b16 v[148:149], v109 offset:12288
    ds_read_b64_tr_b16 v[150:151], v109 offset:14336
    ds_read_b64_tr_b16 v[152:153], v110 offset:12288
    ds_read_b64_tr_b16 v[154:155], v110 offset:14336
    ds_read_b64_tr_b16 v[156:157], v111 offset:12288
    ds_read_b64_tr_b16 v[158:159], v111 offset:14336
    s_waitcnt lgkmcnt(8)
    v_mfma_f32_16x16x32_bf16 v[72:75], v[48:51], v[128:131], v[72:75]
    v_mfma_f32_16x16x32_bf16 v[76:79], v[48:51], v[132:135], v[76:79]
    v_mfma_f32_16x16x32_bf16 v[80:83], v[48:51], v[136:139], v[80:83]
    v_mfma_f32_16x16x32_bf16 v[84:87], v[48:51], v[140:143], v[84:87]
    s_waitcnt vmcnt(12)
    ds_read_b64_tr_b16 v[128:129], v108 offset:16384
    ds_read_b64_tr_b16 v[130:131], v108 offset:18432
    ds_read_b64_tr_b16 v[132:133], v109 offset:16384
    ds_read_b64_tr_b16 v[134:135], v109 offset:18432
    ds_read_b64_tr_b16 v[136:137], v110 offset:16384
    ds_read_b64_tr_b16 v[138:139], v110 offset:18432
    ds_read_b64_tr_b16 v[140:141], v111 offset:16384
    ds_read_b64_tr_b16 v[142:143], v111 offset:18432
    s_waitcnt lgkmcnt(8)
    v_mfma_f32_16x16x32_bf16 v[72:75], v[52:55], v[144:147], v[72:75]
    v_mfma_f32_16x16x32_bf16 v[76:79], v[52:55], v[148:151], v[76:79]
    v_mfma_f32_16x16x32_bf16 v[80:83], v[52:55], v[152:155], v[80:83]
    v_mfma_f32_16x16x32_bf16 v[84:87], v[52:55], v[156:159], v[84:87]
    s_waitcnt vmcnt(8)
    ds_read_b64_tr_b16 v[144:145], v108 offset:20480
    ds_read_b64_tr_b16 v[146:147], v108 offset:22528
    ds_read_b64_tr_b16 v[148:149], v109 offset:20480
    ds_read_b64_tr_b16 v[150:151], v109 offset:22528
    ds_read_b64_tr_b16 v[152:153], v110 offset:20480
    ds_read_b64_tr_b16 v[154:155], v110 offset:22528
    ds_read_b64_tr_b16 v[156:157], v111 offset:20480
    ds_read_b64_tr_b16 v[158:159], v111 offset:22528
    s_waitcnt lgkmcnt(8)
    v_mfma_f32_16x16x32_bf16 v[72:75], v[56:59], v[128:131], v[72:75]
    v_mfma_f32_16x16x32_bf16 v[76:79], v[56:59], v[132:135], v[76:79]
    v_mfma_f32_16x16x32_bf16 v[80:83], v[56:59], v[136:139], v[80:83]
    v_mfma_f32_16x16x32_bf16 v[84:87], v[56:59], v[140:143], v[84:87]
    s_waitcnt vmcnt(4)
    ds_read_b64_tr_b16 v[128:129], v108 offset:24576
    ds_read_b64_tr_b16 v[130:131], v108 offset:26624
    ds_read_b64_tr_b16 v[132:133], v109 offset:24576
    ds_read_b64_tr_b16 v[134:135], v109 offset:26624
    ds_read_b64_tr_b16 v[136:137], v110 offset:24576
    ds_read_b64_tr_b16 v[138:139], v110 offset:26624
    ds_read_b64_tr_b16 v[140:141], v111 offset:24576
    ds_read_b64_tr_b16 v[142:143], v111 offset:26624
    s_waitcnt lgkmcnt(8)
    v_mfma_f32_16x16x32_bf16 v[72:75], v[60:63], v[144:147], v[72:75]
    v_mfma_f32_16x16x32_bf16 v[76:79], v[60:63], v[148:151], v[76:79]
    v_mfma_f32_16x16x32_bf16 v[80:83], v[60:63], v[152:155], v[80:83]
    v_mfma_f32_16x16x32_bf16 v[84:87], v[60:63], v[156:159], v[84:87]
    s_waitcnt vmcnt(0)
    ds_read_b64_tr_b16 v[144:145], v108 offset:28672
    ds_read_b64_tr_b16 v[146:147], v108 offset:30720
    ds_read_b64_tr_b16 v[148:149], v109 offset:28672
    ds_read_b64_tr_b16 v[150:151], v109 offset:30720
    ds_read_b64_tr_b16 v[152:153], v110 offset:28672
    ds_read_b64_tr_b16 v[154:155], v110 offset:30720
    ds_read_b64_tr_b16 v[156:157], v111 offset:28672
    ds_read_b64_tr_b16 v[158:159], v111 offset:30720
    s_waitcnt lgkmcnt(8)
    v_mfma_f32_16x16x32_bf16 v[72:75], v[64:67], v[128:131], v[72:75]
    v_mfma_f32_16x16x32_bf16 v[76:79], v[64:67], v[132:135], v[76:79]
    v_mfma_f32_16x16x32_bf16 v[80:83], v[64:67], v[136:139], v[80:83]
    v_mfma_f32_16x16x32_bf16 v[84:87], v[64:67], v[140:143], v[84:87]
    s_waitcnt lgkmcnt(0)
    v_mfma_f32_16x16x32_bf16 v[72:75], v[68:71], v[144:147], v[72:75]
    v_mfma_f32_16x16x32_bf16 v[76:79], v[68:71], v[148:151], v[76:79]
    v_mfma_f32_16x16x32_bf16 v[80:83], v[68:71], v[152:155], v[80:83]
    v_mfma_f32_16x16x32_bf16 v[84:87], v[68:71], v[156:159], v[84:87]
    v_mov_b32 v49, s50
    v_mov_b32 v51, s50
    s_mov_b32 s56, 0x11111111
    s_mov_b32 s57, 0x11111111
    s_mov_b32 s60, 0xffff0000
    s_mov_b32 s61, 0
    s_mov_b32 s62, 0
    s_mov_b32 s63, 0xffff
    s_mov_b32 s64, 0
    s_mov_b32 s65, 0xffff0000
    s_nop 1
    v_cndmask_b32 v104, v72, v76, s[60:61]
    v_cndmask_b32 v104, v104, v80, s[62:63]
    v_cndmask_b32 v104, v104, v84, s[64:65]
    v_mul_f32 v104, s58, v104
    s_nop 1
    v_mov_b32_dpp v105, v104 quad_perm:[1,0,3,2] row_mask:0xf bank_mask:0xf
    v_cvt_pk_bf16_f32 v48, v104, v105
    s_nop 1
    v_mov_b32_dpp v50, v48 quad_perm:[2,3,0,1] row_mask:0xf bank_mask:0xf
    s_mov_b64 exec, s[56:57]
    buffer_store_dwordx4 v[48:51], v27, s[28:31], s47 offen
    buffer_store_dwordx4 v[48:51], v27, s[28:31], s46 offen sc1
    s_mov_b64 exec, -1
    ds_write_b32 v21, v22 offset:104
    s_branch L_attn
    .p2align 12
L_w23:
    s_setprio 3
    s_waitcnt lgkmcnt(0)
    s_mov_b32 s28, s26
    s_and_b32 s29, s27, 0xffff
    s_mov_b32 s30, 268435456
    s_mov_b32 s31, 0x20000
    s_mov_b32 s32, s4
    s_and_b32 s33, s5, 0xffff
    s_mov_b32 s34, 2048
    s_mov_b32 s35, 0x20000
L_prep:
    s_lshr_b32 s52, s48, 1
    s_lshl_b32 s52, s52, 3
    s_and_b32 s54, s49, 1
    s_lshl_b32 s54, s54, 2
    s_add_u32 s52, s52, s54
    s_and_b32 s54, s48, 1
    s_lshl_b32 s54, s54, 4
    s_lshr_b32 s55, s49, 1
    s_add_u32 s55, s55, s54
    s_lshl_b32 s57, s3, 2
    v_add_u32 v223, s57, v21
    v_lshrrev_b32 v28, 2, v3
    v_cmp_eq_u32 vcc, 0, v28
    s_nop 1
    v_cndmask_b32 v112, 0, -1, vcc
    v_cmp_eq_u32 vcc, 1, v28
    s_nop 1
    v_cndmask_b32 v113, 0, -1, vcc
    v_cmp_eq_u32 vcc, 2, v28
    s_nop 1
    v_cndmask_b32 v114, 0, -1, vcc
    v_cmp_eq_u32 vcc, 3, v28
    s_nop 1
    v_cndmask_b32 v115, 0, -1, vcc
    v_lshrrev_b32 v28, 3, v0
    v_and_b32 v29, 7, v0
    v_add_u32 v30, 0, v28
    v_and_b32 v31, 3, v30
    v_lshlrev_b32 v31, 2, v31
    v_lshrrev_b32 v192, 2, v30
    v_add_u32 v31, v31, v192
    v_lshlrev_b32 v31, 9, v31
    v_lshl_add_u32 v192, v29, 4, v31
    v_lshrrev_b32 v31, 1, v29
    v_lshl_add_u32 v31, v31, 4, v30
    v_lshlrev_b32 v31, 4, v31
    v_and_b32 v30, 1, v29
    v_lshl_add_u32 v31, v30, 3, v31
    s_lshl_b32 s57, s3, 10
    s_add_u32 s57, s57, 131072
    v_add_u32 v194, s57, v31
    v_add_u32 v30, 8, v28
    v_and_b32 v31, 3, v30
    v_lshlrev_b32 v31, 2, v31
    v_lshrrev_b32 v193, 2, v30
    v_add_u32 v31, v31, v193
    v_lshlrev_b32 v31, 9, v31
    v_lshl_add_u32 v193, v29, 4, v31
    v_lshrrev_b32 v31, 1, v29
    v_lshl_add_u32 v31, v31, 4, v30
    v_lshlrev_b32 v31, 4, v31
    v_and_b32 v30, 1, v29
    v_lshl_add_u32 v31, v30, 3, v31
    s_lshl_b32 s57, s3, 10
    s_add_u32 s57, s57, 131072
    v_add_u32 v195, s57, v31
    s_lshl_b32 s44, s52, 11
    s_lshl_b32 s57, s3, 7
    s_add_u32 s44, s44, s57
    s_add_u32 s44, s44, 65536
    s_xor_b32 s57, s48, s49
    s_and_b32 s57, s57, 1
    s_mov_b32 s58, 65536
    s_cmp_eq_u32 s57, 0
    s_cselect_b32 s58, s58, 0
    s_add_u32 s43, s44, s58
    v_lshlrev_b32 v214, 4, v0
    v_add_u32 v196, 131072, v214
    s_lshl_b32 s57, s3, 13
    s_add_u32 s57, s57, 32768
    v_lshlrev_b32 v28, 8, v3
    v_add_u32 v28, s57, v28
    v_xor_b32 v29, v2, v3
    v_lshl_add_u32 v197, v29, 4, v28
    v_xor_b32 v198, 64, v197
    v_xor_b32 v199, 128, v197
    v_xor_b32 v200, 192, v197
    v_lshrrev_b32 v28, 2, v3
    v_lshl_add_u32 v28, v2, 2, v28
    v_and_b32 v29, 7, v28
    v_lshlrev_b32 v29, 5, v29
    v_lshl_add_u32 v28, v28, 8, v29
    v_and_b32 v29, 3, v3
    v_lshl_add_u32 v28, v29, 3, v28
    s_lshl_b32 s57, s3, 13
    s_add_u32 s57, s57, 65536
    v_add_u32 v201, s57, v28
    v_xor_b32 v202, 32, v201
    v_xor_b32 v203, 64, v201
    v_xor_b32 v204, 96, v201
    v_xor_b32 v205, 128, v201
    v_xor_b32 v206, 160, v201
    v_xor_b32 v207, 192, v201
    v_xor_b32 v208, 224, v201
    s_lshl_b32 s57, s3, 11
    s_add_u32 s57, s57, 135168
    v_add_u32 v209, s57, v214
    s_lshl_b32 s57, s3, 3
    s_add_u32 s57, s57, 143360
    v_lshlrev_b32 v28, 5, v3
    v_add_u32 v210, s57, v28
    s_and_b32 s57, s3, 1
    s_lshl_b32 s57, s57, 10
    s_add_u32 s57, s57, 135168
    v_add_u32 v211, s57, v214
    v_and_b32 v28, 3, v3
    v_lshlrev_b32 v29, 5, v28
    v_add_u32 v212, 143360, v29
    v_lshlrev_b32 v28, 14, v28
    v_lshrrev_b32 v29, 3, v3
    v_lshl_add_u32 v28, v29, 13, v28
    v_bfe_u32 v29, v3, 2, 1
    v_lshl_add_u32 v29, v29, 2, v2
    v_lshl_add_u32 v213, v29, 4, v28
    s_lshl_b32 s40, s52, 14
    s_lshl_b32 s57, s55, 8
    s_add_u32 s40, s40, s57
    s_and_b32 s57, s3, 1
    s_lshl_b32 s57, s57, 7
    s_add_u32 s40, s40, s57
    s_add_u32 s40, s40, 262144
    s_lshr_b32 s56, s49, 2
    s_lshl_b32 s57, s48, 3
    s_add_u32 s56, s56, s57
    s_lshl_b32 s41, s56, 13
    s_lshl_b32 s57, s3, 11
    s_add_u32 s41, s41, s57
    s_add_u32 s41, s41, 262144
    v_lshrrev_b32 v28, 2, v3
    v_lshl_add_u32 v29, v28, 2, v2
    v_lshlrev_b32 v29, 9, v29
    v_and_b32 v30, 1, v2
    v_lshl_add_u32 v30, v30, 2, v28
    v_lshl_add_u32 v29, v30, 5, v29
    v_and_b32 v30, 3, v3
    v_lshl_add_u32 v29, v30, 3, v29
    v_add_u32 v29, 98304, v29
    s_lshl_b32 s57, s3, 7
    v_xor_b32 v216, s57, v29
    v_xor_b32 v217, 32, v216
    v_xor_b32 v218, 64, v216
    v_xor_b32 v219, 96, v216
    s_and_b32 s57, s49, 3
    s_lshl_b32 s57, s57, 3
    s_lshl_b32 s58, s3, 1
    s_add_u32 s57, s57, s58
    s_lshl_b32 s42, s57, 13
    s_lshl_b32 s57, s56, 7
    s_add_u32 s42, s42, s57
    s_add_u32 s42, s42, 1048576
    v_lshrrev_b32 v28, 3, v3
    v_lshlrev_b32 v28, 13, v28
    v_and_b32 v29, 7, v3
    v_lshl_add_u32 v220, v29, 4, v28
    v_add_u32 v222, 143616, v214
    s_lshl_b32 s57, s3, 2
    v_add_u32 v221, s57, v222
    s_cmp_eq_u32 s3, 0
    s_cbranch_scc1 L_qproj2
    s_cmp_eq_u32 s3, 1
    s_cbranch_scc1 L_attn
    s_setprio 0
L_wf_5:
    ds_read_b32 v28, v21 offset:92
    ds_read_b32 v29, v21 offset:100
    s_sub_u32 s51, s51, 1
    s_cbranch_scc1 L_abort
    s_sleep 1
    s_waitcnt lgkmcnt(0)
    v_cmp_ne_u32 vcc, 0, v28
    s_cbranch_vccz L_wf_5
    s_setprio 3
    v_readfirstlane_b32 s50, v29
L_attn:
    s_setprio 0
L_wf_6:
    ds_read_b32 v28, v21 offset:104
    s_sub_u32 s51, s51, 1
    s_cbranch_scc1 L_abort
    s_sleep 1
    s_waitcnt lgkmcnt(0)
    v_cmp_ne_u32 vcc, 0, v28
    s_cbranch_vccz L_wf_6
    s_setprio 3
    s_setprio 0
L_wf_7:
    ds_read_b64 v[28:29], v21 offset:72
    s_sub_u32 s51, s51, 1
    s_cbranch_scc1 L_abort
    s_waitcnt lgkmcnt(0)
    v_and_b32 v28, v28, v29
    v_cmp_ne_u32 vcc, 0, v28
    s_cbranch_vccz L_wf_7
    s_setprio 3
    s_mov_b64 s[70:71], -1
    s_mov_b64 s[72:73], -1
    s_mov_b32 s68, 0
    buffer_load_dwordx4 v[128:131], v192, s[28:31], s43 offen sc1
    buffer_load_dwordx4 v[132:135], v193, s[28:31], s43 offen sc1
    ds_write_b32 v223, v22 offset:112
    ds_read_b128 v[40:43], v197 offset:0
    ds_read_b128 v[44:47], v198 offset:0
    ds_read_b128 v[48:51], v199 offset:0
    ds_read_b128 v[52:55], v200 offset:0
    ds_read_b128 v[56:59], v197 offset:4096
    ds_read_b128 v[60:63], v198 offset:4096
    ds_read_b128 v[64:67], v199 offset:4096
    ds_read_b128 v[68:71], v200 offset:4096
    s_branch L_me_9
L_mp_8:
    s_sub_u32 s51, s51, 1
    s_cbranch_scc1 L_abort
    s_cmp_ge_u32 s68, 12
    s_cselect_b32 s43, s44, s43
    s_mov_b64 exec, s[70:71]
    s_cbranch_execz L_sk_10
    buffer_load_dwordx4 v[128:131], v192, s[28:31], s43 offen sc1
L_sk_10:
    s_mov_b64 exec, s[72:73]
    s_cbranch_execz L_sk_11
    buffer_load_dwordx4 v[132:135], v193, s[28:31], s43 offen sc1
L_sk_11:
    s_mov_b64 exec, -1
L_me_9:
    s_add_u32 s68, s68, 1
    s_waitcnt vmcnt(0)
    s_mov_b64 s[66:67], 0
    s_mov_b64 exec, s[70:71]
    s_cbranch_execz L_sc_12
    v_xor_b32 v36, s50, v129
    v_xor_b32 v37, s50, v131
    v_or_b32 v36, v36, v37
    v_cmp_ne_u32 vcc, 0, v36
    s_andn2_b64 exec, exec, vcc
    s_cbranch_execz L_sd_13
    ds_write2_b32 v194, v128, v130 offset0:0 offset1:1
L_sd_13:
    s_mov_b64 s[70:71], vcc
    s_or_b64 s[66:67], s[66:67], vcc
L_sc_12:
    s_mov_b64 exec, s[72:73]
    s_cbranch_execz L_sc_14
    v_xor_b32 v36, s50, v133
    v_xor_b32 v37, s50, v135
    v_or_b32 v36, v36, v37
    v_cmp_ne_u32 vcc, 0, v36
    s_andn2_b64 exec, exec, vcc
    s_cbranch_execz L_sd_15
    ds_write2_b32 v195, v132, v134 offset0:0 offset1:1
L_sd_15:
    s_mov_b64 s[72:73], vcc
    s_or_b64 s[66:67], s[66:67], vcc
L_sc_14:
    s_mov_b64 exec, -1
    s_cmp_lg_u64 s[66:67], 0
    s_cbranch_scc1 L_mp_8
L_qk:
    ds_write_b32 v223, v22 offset:0
L_wf_16:
    ds_read_b128 v[28:31], v21 offset:0
    ds_read_b64 v[32:33], v21 offset:56
    ds_read_b128 v[72:75], v196 offset:0
    ds_read_b128 v[76:79], v196 offset:1024
    ds_read_b128 v[80:83], v196 offset:2048
    ds_read_b128 v[84:87], v196 offset:3072
    s_sub_u32 s51, s51, 1
    s_cbranch_scc1 L_abort
    s_waitcnt lgkmcnt(0)
    v_and_b32 v28, v28, v29
    v_and_b32 v30, v30, v31
    v_and_b32 v28, v28, v30
    v_cmp_ne_u32 vcc, 0, v28
    s_cbranch_vccz L_wf_16
    v_mfma_f32_16x16x32_bf16 v[88:91], v[40:43], v[72:75], 0
    v_mfma_f32_16x16x32_bf16 v[92:95], v[56:59], v[72:75], 0
    v_mfma_f32_16x16x32_bf16 v[88:91], v[44:47], v[76:79], v[88:91]
    v_mfma_f32_16x16x32_bf16 v[92:95], v[60:63], v[76:79], v[92:95]
    v_mfma_f32_16x16x32_bf16 v[88:91], v[48:51], v[80:83], v[88:91]
    v_mfma_f32_16x16x32_bf16 v[92:95], v[64:67], v[80:83], v[92:95]
    v_mfma_f32_16x16x32_bf16 v[88:91], v[52:55], v[84:87], v[88:91]
    v_mfma_f32_16x16x32_bf16 v[92:95], v[68:71], v[84:87], v[92:95]
    v_and_b32 v32, v32, v33
    v_cmp_ne_u32 vcc, 0, v32
    s_mov_b32 s59, 0
    s_cbranch_vccz L_vlate_17
    ds_read_b64_tr_b16 v[160:161], v201 offset:0
    ds_read_b64_tr_b16 v[162:163], v201 offset:4096
    ds_read_b64_tr_b16 v[164:165], v202 offset:0
    ds_read_b64_tr_b16 v[166:167], v202 offset:4096
    ds_read_b64_tr_b16 v[168:169], v203 offset:0
    ds_read_b64_tr_b16 v[170:171], v203 offset:4096
    ds_read_b64_tr_b16 v[172:173], v204 offset:0
    ds_read_b64_tr_b16 v[174:175], v204 offset:4096
    ds_read_b64_tr_b16 v[176:177], v205 offset:0
    ds_read_b64_tr_b16 v[178:179], v205 offset:4096
    ds_read_b64_tr_b16 v[180:181], v206 offset:0
    ds_read_b64_tr_b16 v[182:183], v206 offset:4096
    ds_read_b64_tr_b16 v[184:185], v207 offset:0
    ds_read_b64_tr_b16 v[186:187], v207 offset:4096
    ds_read_b64_tr_b16 v[188:189], v208 offset:0
    ds_read_b64_tr_b16 v[190:191], v208 offset:4096
    s_mov_b32 s59, 1
L_vlate_17:
    v_mov_b32 v44, 0x3f803f80
    v_mov_b32 v45, 0x3f803f80
    v_mov_b32 v46, 0x3f803f80
    v_mov_b32 v47, 0x3f803f80
    s_nop 2
    v_add_f32_dpp v96, v88, v88 row_ror:4 row_mask:0xf bank_mask:0xf
    v_add_f32_dpp v97, v89, v89 row_ror:4 row_mask:0xf bank_mask:0xf
    v_add_f32_dpp v98, v90, v90 row_ror:4 row_mask:0xf bank_mask:0xf
    v_add_f32_dpp v99, v91, v91 row_ror:4 row_mask:0xf bank_mask:0xf
    v_add_f32_dpp v100, v92, v92 row_ror:4 row_mask:0xf bank_mask:0xf
    v_add_f32_dpp v101, v93, v93 row_ror:4 row_mask:0xf bank_mask:0xf
    v_add_f32_dpp v102, v94, v94 row_ror:4 row_mask:0xf bank_mask:0xf
    v_add_f32_dpp v103, v95, v95 row_ror:4 row_mask:0xf bank_mask:0xf
    v_add_f32_dpp v88, v96, v96 row_ror:8 row_mask:0xf bank_mask:0xf
    v_add_f32_dpp v89, v97, v97 row_ror:8 row_mask:0xf bank_mask:0xf
    v_add_f32_dpp v90, v98, v98 row_ror:8 row_mask:0xf bank_mask:0xf
    v_add_f32_dpp v91, v99, v99 row_ror:8 row_mask:0xf bank_mask:0xf
    v_add_f32_dpp v92, v100, v100 row_ror:8 row_mask:0xf bank_mask:0xf
    v_add_f32_dpp v93, v101, v101 row_ror:8 row_mask:0xf bank_mask:0xf
    v_add_f32_dpp v94, v102, v102 row_ror:8 row_mask:0xf bank_mask:0xf
    v_add_f32_dpp v95, v103, v103 row_ror:8 row_mask:0xf bank_mask:0xf
    v_max3_f32 v96, v88, v89, v90
    v_max3_f32 v97, v91, v92, v93
    v_max3_f32 v96, v96, v94, v95
    v_max_f32 v96, v96, v97
    v_mov_b32 v97, v96
    s_nop 1
    v_permlane32_swap_b32 v96, v97
    v_max_f32 v96, v96, v97
    v_mov_b32 v97, v96
    s_nop 1
    v_permlane16_swap_b32 v96, v97
    v_max_f32 v96, v96, v97
    v_sub_f32 v88, v88, v96
    v_sub_f32 v89, v89, v96
    v_sub_f32 v90, v90, v96
    v_sub_f32 v91, v91, v96
    v_sub_f32 v92, v92, v96
    v_sub_f32 v93, v93, v96
    v_sub_f32 v94, v94, v96
    v_sub_f32 v95, v95, v96
    v_exp_f32 v88, v88
    v_exp_f32 v89, v89
    v_exp_f32 v90, v90
    v_exp_f32 v91, v91
    v_exp_f32 v92, v92
    v_exp_f32 v93, v93
    v_exp_f32 v94, v94
    v_exp_f32 v95, v95
    s_nop 0
    v_cvt_pk_bf16_f32 v100, v88, v89
    v_cvt_pk_bf16_f32 v101, v90, v91
    v_cvt_pk_bf16_f32 v102, v92, v93
    v_cvt_pk_bf16_f32 v103, v94, v95
    s_cmp_lg_u32 s59, 0
    s_cbranch_scc1 L_vok_18
L_wf_19:
    ds_read_b64 v[28:29], v21 offset:56
    s_sub_u32 s51, s51, 1
    s_cbranch_scc1 L_abort
    s_waitcnt lgkmcnt(0)
    v_and_b32 v28, v28, v29
    v_cmp_ne_u32 vcc, 0, v28
    s_cbranch_vccz L_wf_19
    ds_read_b64_tr_b16 v[160:161], v201 offset:0
    ds_read_b64_tr_b16 v[162:163], v201 offset:4096
    ds_read_b64_tr_b16 v[164:165], v202 offset:0
    ds_read_b64_tr_b16 v[166:167], v202 offset:4096
    ds_read_b64_tr_b16 v[168:169], v203 offset:0
    ds_read_b64_tr_b16 v[170:171], v203 offset:4096
    ds_read_b64_tr_b16 v[172:173], v204 offset:0
    ds_read_b64_tr_b16 v[174:175], v204 offset:4096
    ds_read_b64_tr_b16 v[176:177], v205 offset:0
    ds_read_b64_tr_b16 v[178:179], v205 offset:4096
    ds_read_b64_tr_b16 v[180:181], v206 offset:0
    ds_read_b64_tr_b16 v[182:183], v206 offset:4096
    ds_read_b64_tr_b16 v[184:185], v207 offset:0
    ds_read_b64_tr_b16 v[186:187], v207 offset:4096
    ds_read_b64_tr_b16 v[188:189], v208 offset:0
    ds_read_b64_tr_b16 v[190:191], v208 offset:4096
L_vok_18:
    v_and_b32 v72, v100, v112
    v_and_b32 v73, v101, v112
    v_and_b32 v74, v102, v112
    v_and_b32 v75, v103, v112
    v_and_b32 v76, v100, v113
    v_and_b32 v77, v101, v113
    v_and_b32 v78, v102, v113
    v_and_b32 v79, v103, v113
    s_waitcnt lgkmcnt(0)
    v_mfma_f32_16x16x32_bf16 v[104:107], v[160:163], v[72:75], 0
    v_and_b32 v80, v100, v114
    v_and_b32 v81, v101, v114
    v_and_b32 v82, v102, v114
    v_and_b32 v83, v103, v114
    v_mfma_f32_16x16x32_bf16 v[104:107], v[164:167], v[76:79], v[104:107]
    v_and_b32 v84, v100, v115
    v_and_b32 v85, v101, v115
    v_and_b32 v86, v102, v115
    v_and_b32 v87, v103, v115
    v_mfma_f32_16x16x32_bf16 v[108:111], v[168:171], v[72:75], 0
    v_mfma_f32_16x16x32_bf16 v[108:111], v[172:175], v[76:79], v[108:111]
    v_mfma_f32_16x16x32_bf16 v[104:107], v[176:179], v[80:83], v[104:107]
    v_mfma_f32_16x16x32_bf16 v[104:107], v[180:183], v[84:87], v[104:107]
    v_mfma_f32_16x16x32_bf16 v[108:111], v[184:187], v[80:83], v[108:111]
    v_mfma_f32_16x16x32_bf16 v[108:111], v[188:191], v[84:87], v[108:111]
    v_mfma_f32_16x16x32_bf16 v[92:95], v[44:47], v[100:103], 0
    s_nop 5
    ds_write_b128 v209, v[104:107]
    ds_write_b128 v209, v[108:111] offset:1024
    v_mov_b32 v97, v92
    s_mov_b64 exec, 0xf
    ds_write_b64 v210, v[96:97]
    s_mov_b64 exec, -1
    ds_write_b32 v223, v22 offset:16
    s_lshr_b32 s60, s50, 0
    s_and_b32 s60, s60, 0xff
    s_lshr_b32 s61, s50, 8
    s_and_b32 s61, s61, 0xff
    s_lshr_b32 s62, s50, 16
    s_and_b32 s62, s62, 0xff
    s_lshr_b32 s63, s50, 24
    s_and_b32 s63, s63, 0xff
    s_mov_b32 s64, 0x07060500
    s_mov_b32 s59, 0
    s_cmp_ge_u32 s3, 2
    s_cbranch_scc1 L_e2
    v_mov_b32 v63, s50
L_wf_20:
    ds_read_b128 v[28:31], v21 offset:16
    ds_read_b128 v[32:35], v211 offset:0
    ds_read_b128 v[36:39], v211 offset:2048
    ds_read_b128 v[40:43], v211 offset:4096
    ds_read_b128 v[44:47], v211 offset:6144
    ds_read_b128 v[48:51], v212
    ds_read_b128 v[52:55], v212 offset:16
    s_sub_u32 s51, s51, 1
    s_cbranch_scc1 L_abort
    s_waitcnt lgkmcnt(0)
    v_and_b32 v28, v28, v29
    v_and_b32 v30, v30, v31
    v_and_b32 v28, v28, v30
    v_cmp_ne_u32 vcc, 0, v28
    s_cbranch_vccz L_wf_20
    v_max3_f32 v56, v48, v50, v52
    v_max_f32 v56, v56, v54
    v_sub_f32 v48, v48, v56
    v_sub_f32 v50, v50, v56
    v_sub_f32 v52, v52, v56
    v_sub_f32 v54, v54, v56
    v_exp_f32 v48, v48
    v_exp_f32 v50, v50
    v_exp_f32 v52, v52
    v_exp_f32 v54, v54
    s_nop 0
    v_mul_f32 v57, v48, v49
    v_mul_f32 v32, v32, v48
    v_mul_f32 v33, v33, v48
    v_mul_f32 v34, v34, v48
    v_mul_f32 v35, v35, v48
    v_fmac_f32 v57, v50, v51
    v_fmac_f32 v57, v52, v53
    v_fmac_f32 v57, v54, v55
    v_fmac_f32 v32, v36, v50
    v_fmac_f32 v33, v37, v50
    v_fmac_f32 v34, v38, v50
    v_fmac_f32 v35, v39, v50
    v_rcp_f32 v58, v57
    v_log_f32 v59, v57
    v_fmac_f32 v32, v40, v52
    v_fmac_f32 v33, v41, v52
    v_fmac_f32 v34, v42, v52
    v_fmac_f32 v35, v43, v52
    v_fmac_f32 v32, v44, v54
    v_fmac_f32 v33, v45, v54
    v_fmac_f32 v34, v46, v54
    v_fmac_f32 v35, v47, v54
    v_add_f32 v62, v56, v59
    v_mul_f32 v32, v32, v58
    v_mul_f32 v33, v33, v58
    v_mul_f32 v34, v34, v58
    v_mul_f32 v35, v35, v58
    v_cvt_pk_bf16_f32 v60, v32, v33
    v_cvt_pk_bf16_f32 v61, v34, v35
    buffer_store_dwordx4 v[60:63], v213, s[28:31], s40 offen sc1
    ds_write_b32 v223, v22 offset:80
L_e2:
    v_mov_b32 v8, s60
    v_mov_b32 v9, s61
    v_mov_b32 v10, s62
    v_mov_b32 v11, s63
    s_setprio 0
L_wf_21:
    ds_read_b64 v[28:29], v21 offset:80
    s_sub_u32 s51, s51, 1
    s_cbranch_scc1 L_abort
    s_waitcnt lgkmcnt(0)
    v_and_b32 v28, v28, v29
    v_cmp_ne_u32 vcc, 0, v28
    s_cbranch_vccz L_wf_21
    s_setprio 3
    s_sleep 24
    s_mov_b64 s[70:71], -1
    s_mov_b64 s[72:73], -1
    s_mov_b32 s69, 0
    buffer_load_dwordx4 v[128:131], v214, s[28:31], s41 offen offset:0 sc1
    buffer_load_dwordx4 v[132:135], v214, s[28:31], s41 offen offset:1024 sc1
    s_cmp_lg_u32 s59, 0
    s_cbranch_scc1 L_wo_24
    ds_read_b64 v[28:29], v21 offset:64
    s_waitcnt lgkmcnt(0)
    v_and_b32 v28, v28, v29
    v_cmp_ne_u32 vcc, 0, v28
    s_cbranch_vccz L_wo_24
    ds_read_b64_tr_b16 v[40:41], v216 offset:0
    ds_read_b64_tr_b16 v[42:43], v216 offset:8192
    ds_read_b64_tr_b16 v[44:45], v216 offset:16384
    ds_read_b64_tr_b16 v[46:47], v216 offset:24576
    ds_read_b64_tr_b16 v[48:49], v217 offset:0
    ds_read_b64_tr_b16 v[50:51], v217 offset:8192
    ds_read_b64_tr_b16 v[52:53], v217 offset:16384
    ds_read_b64_tr_b16 v[54:55], v217 offset:24576
    ds_read_b64_tr_b16 v[56:57], v218 offset:0
    ds_read_b64_tr_b16 v[58:59], v218 offset:8192
    ds_read_b64_tr_b16 v[60:61], v218 offset:16384
    ds_read_b64_tr_b16 v[62:63], v218 offset:24576
    ds_read_b64_tr_b16 v[64:65], v219 offset:0
    ds_read_b64_tr_b16 v[66:67], v219 offset:8192
    ds_read_b64_tr_b16 v[68:69], v219 offset:16384
    ds_read_b64_tr_b16 v[70:71], v219 offset:24576
    s_mov_b32 s59, 1
L_wo_24:
    s_branch L_me_23
L_mp_22:
    s_sub_u32 s51, s51, 1
    s_cbranch_scc1 L_abort
    s_cmp_lg_u32 s59, 0
    s_cbranch_scc1 L_wo_25
    ds_read_b64 v[28:29], v21 offset:64
    s_waitcnt lgkmcnt(0)
    v_and_b32 v28, v28, v29
    v_cmp_ne_u32 vcc, 0, v28
    s_cbranch_vccz L_wo_25
    ds_read_b64_tr_b16 v[40:41], v216 offset:0
    ds_read_b64_tr_b16 v[42:43], v216 offset:8192
    ds_read_b64_tr_b16 v[44:45], v216 offset:16384
    ds_read_b64_tr_b16 v[46:47], v216 offset:24576
    ds_read_b64_tr_b16 v[48:49], v217 offset:0
    ds_read_b64_tr_b16 v[50:51], v217 offset:8192
    ds_read_b64_tr_b16 v[52:53], v217 offset:16384
    ds_read_b64_tr_b16 v[54:55], v217 offset:24576
    ds_read_b64_tr_b16 v[56:57], v218 offset:0
    ds_read_b64_tr_b16 v[58:59], v218 offset:8192
    ds_read_b64_tr_b16 v[60:61], v218 offset:16384
    ds_read_b64_tr_b16 v[62:63], v218 offset:24576
    ds_read_b64_tr_b16 v[64:65], v219 offset:0
    ds_read_b64_tr_b16 v[66:67], v219 offset:8192
    ds_read_b64_tr_b16 v[68:69], v219 offset:16384
    ds_read_b64_tr_b16 v[70:71], v219 offset:24576
    s_mov_b32 s59, 1
L_wo_25:
    s_mov_b64 exec, s[70:71]
    s_cbranch_execz L_sk_26
    buffer_load_dwordx4 v[128:131], v214, s[28:31], s41 offen offset:0 sc1
L_sk_26:
    s_mov_b64 exec, s[72:73]
    s_cbranch_execz L_sk_27
    buffer_load_dwordx4 v[132:135], v214, s[28:31], s41 offen offset:1024 sc1
L_sk_27:
    s_mov_b64 exec, -1
L_me_23:
    s_add_u32 s69, s69, 1
    s_waitcnt vmcnt(0)
    s_mov_b64 s[66:67], 0
    s_mov_b64 exec, s[70:71]
    s_cbranch_execz L_sc_28
    v_cmp_ne_u32 vcc, s50, v131
    s_mov_b64 s[70:71], vcc
    s_or_b64 s[66:67], s[66:67], vcc
L_sc_28:
    s_mov_b64 exec, s[72:73]
    s_cbranch_execz L_sc_29
    v_cmp_ne_u32 vcc, s50, v135
    s_mov_b64 s[72:73], vcc
    s_or_b64 s[66:67], s[66:67], vcc
L_sc_29:
    s_mov_b64 exec, -1
    s_cmp_lg_u64 s[66:67], 0
    s_cbranch_scc1 L_mp_22
    v_max_f32 v7, v130, v134
    v_mov_b32 v20, 0xffff0000
    v_lshlrev_b32 v16, 16, v128
    v_and_b32 v17, v20, v128
    v_mov_b32 v6, v7
    s_nop 1
    v_permlane32_swap_b32 v7, v6
    v_max_f32 v7, v7, v6
    v_mov_b32 v6, v7
    s_nop 1
    v_permlane16_swap_b32 v7, v6
    v_max_f32 v7, v7, v6
    v_sub_f32 v130, v130, v7
    v_sub_f32 v134, v134, v7
    v_lshlrev_b32 v18, 16, v129
    v_and_b32 v19, v20, v129
    v_exp_f32 v130, v130
    v_exp_f32 v134, v134
    v_lshlrev_b32 v24, 16, v132
    v_and_b32 v25, v20, v132
    v_lshlrev_b32 v26, 16, v133
    v_and_b32 v27, v20, v133
    v_mul_f32 v12, v16, v130
    v_mul_f32 v13, v17, v130
    v_mul_f32 v14, v18, v130
    v_mul_f32 v15, v19, v130
    v_add_f32 v5, v130, v134
    v_fmac_f32 v12, v24, v134
    v_fmac_f32 v13, v25, v134
    v_fmac_f32 v14, v26, v134
    v_fmac_f32 v15, v27, v134
    v_mov_b32 v4, v7
    v_mov_b32 v6, v5
    s_nop 1
    v_permlane32_swap_b32 v5, v6
    v_add_f32 v5, v5, v6
    v_mov_b32 v6, v5
    s_nop 1
    v_permlane16_swap_b32 v5, v6
    v_add_f32 v5, v5, v6
    v_permlane32_swap_b32 v12, v14
    v_permlane32_swap_b32 v13, v15
    v_add_f32 v12, v12, v14
    v_add_f32 v13, v13, v15
    s_nop 1
    v_permlane16_swap_b32 v12, v13
    v_add_f32 v12, v12, v13
    ds_write_b32 v221, v12
    s_lshl_b32 s57, s3, 3
    s_add_u32 s57, s57, 144640
    v_mov_b32 v6, s57
    s_mov_b64 exec, 1
    ds_write_b64 v6, v[4:5]
    s_mov_b64 exec, -1
    ds_write_b32 v223, v22 offset:32
    v_mov_b32 v6, 144640
L_wf_30:
    ds_read_b128 v[28:31], v21 offset:32
    ds_read_b128 v[12:15], v222
    ds_read_b128 v[24:27], v6
    ds_read_b128 v[72:75], v6 offset:16
    s_sub_u32 s51, s51, 1
    s_cbranch_scc1 L_abort
    s_waitcnt lgkmcnt(0)
    v_and_b32 v28, v28, v29
    v_and_b32 v30, v30, v31
    v_and_b32 v28, v28, v30
    v_cmp_ne_u32 vcc, 0, v28
    s_cbranch_vccz L_wf_30
    v_max3_f32 v7, v24, v26, v72
    v_max_f32 v7, v7, v74
    v_sub_f32 v24, v24, v7
    v_sub_f32 v26, v26, v7
    v_sub_f32 v72, v72, v7
    v_sub_f32 v74, v74, v7
    v_exp_f32 v24, v24
    v_exp_f32 v26, v26
    v_exp_f32 v72, v72
    v_exp_f32 v74, v74
    s_nop 0
    v_mul_f32 v5, v24, v25
    v_mul_f32 v12, v12, v24
    v_fmac_f32 v5, v26, v27
    v_fmac_f32 v12, v13, v26
    v_fmac_f32 v5, v72, v73
    v_fmac_f32 v12, v14, v72
    v_fmac_f32 v5, v74, v75
    v_fmac_f32 v12, v15, v74
    v_rcp_f32 v5, v5
    s_nop 0
    v_mul_f32 v12, v12, v5
    s_nop 1
    v_mov_b32_dpp v13, v12 quad_perm:[1,0,3,2] row_mask:0xf bank_mask:0xf
    v_cvt_pk_bf16_f32 v12, v12, v13
    s_nop 1
    v_mov_b32_dpp v76, v12 row_newbcast:0 row_mask:0xf bank_mask:0xf
    v_mov_b32_dpp v77, v12 row_newbcast:2 row_mask:0xf bank_mask:0xf
    v_mov_b32_dpp v78, v12 row_newbcast:4 row_mask:0xf bank_mask:0xf
    v_mov_b32_dpp v79, v12 row_newbcast:6 row_mask:0xf bank_mask:0xf
    v_mov_b32_dpp v80, v12 row_newbcast:8 row_mask:0xf bank_mask:0xf
    v_mov_b32_dpp v81, v12 row_newbcast:10 row_mask:0xf bank_mask:0xf
    v_mov_b32_dpp v82, v12 row_newbcast:12 row_mask:0xf bank_mask:0xf
    v_mov_b32_dpp v83, v12 row_newbcast:14 row_mask:0xf bank_mask:0xf
    s_cmp_lg_u32 s59, 0
    s_cbranch_scc1 L_wook_31
L_wf_32:
    ds_read_b64 v[28:29], v21 offset:64
    s_sub_u32 s51, s51, 1
    s_cbranch_scc1 L_abort
    s_waitcnt lgkmcnt(0)
    v_and_b32 v28, v28, v29
    v_cmp_ne_u32 vcc, 0, v28
    s_cbranch_vccz L_wf_32
    ds_read_b64_tr_b16 v[40:41], v216 offset:0
    ds_read_b64_tr_b16 v[42:43], v216 offset:8192
    ds_read_b64_tr_b16 v[44:45], v216 offset:16384
    ds_read_b64_tr_b16 v[46:47], v216 offset:24576
    ds_read_b64_tr_b16 v[48:49], v217 offset:0
    ds_read_b64_tr_b16 v[50:51], v217 offset:8192
    ds_read_b64_tr_b16 v[52:53], v217 offset:16384
    ds_read_b64_tr_b16 v[54:55], v217 offset:24576
    ds_read_b64_tr_b16 v[56:57], v218 offset:0
    ds_read_b64_tr_b16 v[58:59], v218 offset:8192
    ds_read_b64_tr_b16 v[60:61], v218 offset:16384
    ds_read_b64_tr_b16 v[62:63], v218 offset:24576
    ds_read_b64_tr_b16 v[64:65], v219 offset:0
    ds_read_b64_tr_b16 v[66:67], v219 offset:8192
    ds_read_b64_tr_b16 v[68:69], v219 offset:16384
    ds_read_b64_tr_b16 v[70:71], v219 offset:24576
    s_waitcnt lgkmcnt(0)
L_wook_31:
    v_mfma_f32_16x16x32_bf16 v[136:139], v[76:79], v[40:43], 0
    v_mfma_f32_16x16x32_bf16 v[140:143], v[76:79], v[48:51], 0
    v_mfma_f32_16x16x32_bf16 v[144:147], v[76:79], v[56:59], 0
    v_mfma_f32_16x16x32_bf16 v[148:151], v[76:79], v[64:67], 0
    v_mfma_f32_16x16x32_bf16 v[136:139], v[80:83], v[44:47], v[136:139]
    v_mfma_f32_16x16x32_bf16 v[140:143], v[80:83], v[52:55], v[140:143]
    v_mfma_f32_16x16x32_bf16 v[144:147], v[80:83], v[60:63], v[144:147]
    v_mfma_f32_16x16x32_bf16 v[148:151], v[80:83], v[68:71], v[148:151]
    s_mov_b64 exec, 0xffff
    s_nop 3
    v_perm_b32 v4, v136, v8, s64
    v_perm_b32 v5, v140, v9, s64
    v_perm_b32 v6, v144, v10, s64
    v_perm_b32 v7, v148, v11, s64
    buffer_store_dwordx4 v[4:7], v220, s[28:31], s42 offen sc1
    s_mov_b64 exec, -1
    ds_write_b32 v21, v22 offset:108
    s_waitcnt lgkmcnt(0)
    s_endpgm
L_loader:
    s_setprio 2
    s_sub_u32 s52, s3, 4
    s_lshr_b32 s53, s48, 1
    s_lshl_b32 s53, s53, 24
    s_and_b32 s54, s48, 1
    s_lshl_b32 s54, s54, 4
    s_lshr_b32 s55, s49, 1
    s_add_u32 s54, s54, s55
    s_lshl_b32 s54, s54, 15
    s_add_u32 s53, s53, s54
    s_add_u32 s53, s53, 15728640
    s_lshl_b32 s54, s52, 14
    s_add_u32 s53, s53, s54
    s_lshr_b32 s55, s49, 2
    s_lshl_b32 s56, s48, 3
    s_add_u32 s55, s55, s56
    s_lshl_b32 s55, s55, 17
    s_and_b32 s56, s49, 3
    s_lshl_b32 s56, s56, 9
    s_add_u32 s55, s55, s56
    s_lshl_b32 s56, s52, 16
    s_add_u32 s55, s55, s56
    s_lshl_b32 s57, s52, 14
    v_add_u32 v4, 0, v2
    v_xor_b32 v4, v4, v3
    v_lshlrev_b32 v4, 4, v4
    v_lshlrev_b32 v5, 8, v2
    v_add_u32 v8, v4, v5
    v_add_u32 v4, 4, v2
    v_xor_b32 v4, v4, v3
    v_lshlrev_b32 v4, 4, v4
    v_lshlrev_b32 v5, 8, v2
    v_add_u32 v9, v4, v5
    v_add_u32 v4, 8, v2
    v_xor_b32 v4, v4, v3
    v_lshlrev_b32 v4, 4, v4
    v_lshlrev_b32 v5, 8, v2
    v_add_u32 v10, v4, v5
    v_add_u32 v4, 12, v2
    v_xor_b32 v4, v4, v3
    v_lshlrev_b32 v4, 4, v4
    v_lshlrev_b32 v5, 8, v2
    v_add_u32 v11, v4, v5
    v_add_u32 v4, 0, v2
    v_lshrrev_b32 v5, 1, v3
    v_xor_b32 v4, v4, v5
    v_lshlrev_b32 v4, 1, v4
    v_and_b32 v5, 1, v3
    v_or_b32 v4, v4, v5
    v_lshlrev_b32 v4, 4, v4
    v_lshlrev_b32 v5, 8, v2
    v_add_u32 v12, v4, v5
    v_add_u32 v4, 4, v2
    v_lshrrev_b32 v5, 1, v3
    v_xor_b32 v4, v4, v5
    v_lshlrev_b32 v4, 1, v4
    v_and_b32 v5, 1, v3
    v_or_b32 v4, v4, v5
    v_lshlrev_b32 v4, 4, v4
    v_lshlrev_b32 v5, 8, v2
    v_add_u32 v13, v4, v5
    v_lshrrev_b32 v6, 5, v0
    v_and_b32 v7, 31, v0
    v_lshlrev_b32 v4, 2, v6
    v_add_u32 v4, 0, v4
    v_lshrrev_b32 v5, 1, v7
    v_xor_b32 v4, v4, v5
    v_lshlrev_b32 v4, 1, v4
    v_and_b32 v5, 1, v7
    v_or_b32 v4, v4, v5
    v_lshlrev_b32 v4, 4, v4
    v_lshlrev_b32 v5, 11, v6
    v_add_u32 v16, v4, v5
    v_lshlrev_b32 v4, 2, v6
    v_add_u32 v4, 1, v4
    v_lshrrev_b32 v5, 1, v7
    v_xor_b32 v4, v4, v5
    v_lshlrev_b32 v4, 1, v4
    v_and_b32 v5, 1, v7
    v_or_b32 v4, v4, v5
    v_lshlrev_b32 v4, 4, v4
    v_lshlrev_b32 v5, 11, v6
    v_add_u32 v17, v4, v5
    v_lshlrev_b32 v4, 2, v6
    v_add_u32 v4, 2, v4
    v_lshrrev_b32 v5, 1, v7
    v_xor_b32 v4, v4, v5
    v_lshlrev_b32 v4, 1, v4
    v_and_b32 v5, 1, v7
    v_or_b32 v4, v4, v5
    v_lshlrev_b32 v4, 4, v4
    v_lshlrev_b32 v5, 11, v6
    v_add_u32 v18, v4, v5
    v_lshlrev_b32 v4, 2, v6
    v_add_u32 v4, 3, v4
    v_lshrrev_b32 v5, 1, v7
    v_xor_b32 v4, v4, v5
    v_lshlrev_b32 v4, 1, v4
    v_and_b32 v5, 1, v7
    v_or_b32 v4, v4, v5
    v_lshlrev_b32 v4, 4, v4
    v_lshlrev_b32 v5, 11, v6
    v_add_u32 v19, v4, v5
    s_lshl_b32 s58, s52, 2
    v_add_u32 v20, s58, v21
    s_waitcnt lgkmcnt(0)
    s_mov_b32 s36, s6
    s_and_b32 s37, s7, 0xffff
    s_mov_b32 s38, 67108864
    s_mov_b32 s39, 0x20000
    s_mov_b32 s40, s8
    s_and_b32 s41, s9, 0xffff
    s_mov_b32 s42, 67108864
    s_mov_b32 s43, 0x20000
    s_mov_b32 s44, s12
    s_and_b32 s45, s13, 0xffff
    s_mov_b32 s46, 8388608
    s_mov_b32 s47, 0x20000
    s_add_u32 m0, s57, 32768
    s_add_u32 s58, s53, 0
    buffer_load_dwordx4 v8, s[36:39], s58 offen nt lds
    s_add_u32 m0, s57, 33792
    s_add_u32 s58, s53, 1024
    buffer_load_dwordx4 v9, s[36:39], s58 offen nt lds
    s_add_u32 m0, s57, 34816
    s_add_u32 s58, s53, 2048
    buffer_load_dwordx4 v10, s[36:39], s58 offen nt lds
    s_add_u32 m0, s57, 35840
    s_add_u32 s58, s53, 3072
    buffer_load_dwordx4 v11, s[36:39], s58 offen nt lds
    s_add_u32 m0, s57, 36864
    s_add_u32 s58, s53, 4096
    buffer_load_dwordx4 v8, s[36:39], s58 offen nt lds
    s_add_u32 m0, s57, 37888
    s_add_u32 s58, s53, 5120
    buffer_load_dwordx4 v9, s[36:39], s58 offen nt lds
    s_add_u32 m0, s57, 38912
    s_add_u32 s58, s53, 6144
    buffer_load_dwordx4 v10, s[36:39], s58 offen nt lds
    s_add_u32 m0, s57, 39936
    s_add_u32 s58, s53, 7168
    buffer_load_dwordx4 v11, s[36:39], s58 offen nt lds
    s_add_u32 m0, s57, 40960
    s_add_u32 s58, s53, 8192
    buffer_load_dwordx4 v8, s[36:39], s58 offen nt lds
    s_add_u32 m0, s57, 41984
    s_add_u32 s58, s53, 9216
    buffer_load_dwordx4 v9, s[36:39], s58 offen nt lds
    s_add_u32 m0, s57, 43008
    s_add_u32 s58, s53, 10240
    buffer_load_dwordx4 v10, s[36:39], s58 offen nt lds
    s_add_u32 m0, s57, 44032
    s_add_u32 s58, s53, 11264
    buffer_load_dwordx4 v11, s[36:39], s58 offen nt lds
    s_add_u32 m0, s57, 45056
    s_add_u32 s58, s53, 12288
    buffer_load_dwordx4 v8, s[36:39], s58 offen nt lds
    s_add_u32 m0, s57, 46080
    s_add_u32 s58, s53, 13312
    buffer_load_dwordx4 v9, s[36:39], s58 offen nt lds
    s_add_u32 m0, s57, 47104
    s_add_u32 s58, s53, 14336
    buffer_load_dwordx4 v10, s[36:39], s58 offen nt lds
    s_add_u32 m0, s57, 48128
    s_add_u32 s58, s53, 15360
    buffer_load_dwordx4 v11, s[36:39], s58 offen nt lds
    s_waitcnt vmcnt(15)
    s_add_u32 m0, s57, 65536
    s_add_u32 s58, s53, 0
    buffer_load_dwordx4 v12, s[40:43], s58 offen nt lds
    s_waitcnt vmcnt(15)
    s_add_u32 m0, s57, 66560
    s_add_u32 s58, s53, 1024
    buffer_load_dwordx4 v13, s[40:43], s58 offen nt lds
    s_waitcnt vmcnt(15)
    s_add_u32 m0, s57, 67584
    s_add_u32 s58, s53, 2048
    buffer_load_dwordx4 v12, s[40:43], s58 offen nt lds
    s_waitcnt vmcnt(15)
    s_add_u32 m0, s57, 68608
    s_add_u32 s58, s53, 3072
    buffer_load_dwordx4 v13, s[40:43], s58 offen nt lds
    s_waitcnt vmcnt(15)
    s_add_u32 m0, s57, 69632
    s_add_u32 s58, s53, 4096
    buffer_load_dwordx4 v12, s[40:43], s58 offen nt lds
    s_waitcnt vmcnt(15)
    s_add_u32 m0, s57, 70656
    s_add_u32 s58, s53, 5120
    buffer_load_dwordx4 v13, s[40:43], s58 offen nt lds
    s_waitcnt vmcnt(15)
    s_add_u32 m0, s57, 71680
    s_add_u32 s58, s53, 6144
    buffer_load_dwordx4 v12, s[40:43], s58 offen nt lds
    s_waitcnt vmcnt(15)
    s_add_u32 m0, s57, 72704
    s_add_u32 s58, s53, 7168
    buffer_load_dwordx4 v13, s[40:43], s58 offen nt lds
    s_waitcnt vmcnt(15)
    s_add_u32 m0, s57, 73728
    s_add_u32 s58, s53, 8192
    buffer_load_dwordx4 v12, s[40:43], s58 offen nt lds
    s_waitcnt vmcnt(15)
    s_add_u32 m0, s57, 74752
    s_add_u32 s58, s53, 9216
    buffer_load_dwordx4 v13, s[40:43], s58 offen nt lds
    s_waitcnt vmcnt(15)
    s_add_u32 m0, s57, 75776
    s_add_u32 s58, s53, 10240
    buffer_load_dwordx4 v12, s[40:43], s58 offen nt lds
    s_waitcnt vmcnt(15)
    s_add_u32 m0, s57, 76800
    s_add_u32 s58, s53, 11264
    buffer_load_dwordx4 v13, s[40:43], s58 offen nt lds
    s_waitcnt vmcnt(15)
    s_add_u32 m0, s57, 77824
    s_add_u32 s58, s53, 12288
    buffer_load_dwordx4 v12, s[40:43], s58 offen nt lds
    s_waitcnt vmcnt(15)
    s_add_u32 m0, s57, 78848
    s_add_u32 s58, s53, 13312
    buffer_load_dwordx4 v13, s[40:43], s58 offen nt lds
    s_waitcnt vmcnt(15)
    s_add_u32 m0, s57, 79872
    s_add_u32 s58, s53, 14336
    buffer_load_dwordx4 v12, s[40:43], s58 offen nt lds
    s_waitcnt vmcnt(15)
    ds_write_b32 v20, v22 offset:48
    s_add_u32 m0, s57, 80896
    s_add_u32 s58, s53, 15360
    buffer_load_dwordx4 v13, s[40:43], s58 offen nt lds
    ds_write_b32 v20, v22 offset:72
L_wf_33:
    ds_read_b128 v[24:27], v21 offset:112
    s_sub_u32 s51, s51, 1
    s_cbranch_scc1 L_abort
    s_waitcnt lgkmcnt(0)
    v_and_b32 v24, v24, v25
    v_and_b32 v26, v26, v27
    v_and_b32 v24, v24, v26
    v_cmp_ne_u32 vcc, 0, v24
    s_cbranch_vccz L_wf_33
    s_add_u32 m0, s57, 98304
    s_add_u32 s58, s55, 0
    buffer_load_dwordx4 v16, s[44:47], s58 offen nt lds
    s_add_u32 m0, s57, 99328
    s_add_u32 s58, s55, 4096
    buffer_load_dwordx4 v16, s[44:47], s58 offen nt lds
    s_add_u32 m0, s57, 100352
    s_add_u32 s58, s55, 8192
    buffer_load_dwordx4 v17, s[44:47], s58 offen nt lds
    s_waitcnt vmcnt(3)
    ds_write_b32 v20, v22 offset:56
L_wf_34:
    ds_read_b128 v[24:27], v21 offset:0
    s_sub_u32 s51, s51, 1
    s_cbranch_scc1 L_abort
    s_waitcnt lgkmcnt(0)
    v_and_b32 v24, v24, v25
    v_and_b32 v26, v26, v27
    v_and_b32 v24, v24, v26
    v_cmp_ne_u32 vcc, 0, v24
    s_cbranch_vccz L_wf_34
    s_add_u32 m0, s57, 101376
    s_add_u32 s58, s55, 12288
    buffer_load_dwordx4 v17, s[44:47], s58 offen nt lds
    s_add_u32 m0, s57, 102400
    s_add_u32 s58, s55, 16384
    buffer_load_dwordx4 v18, s[44:47], s58 offen nt lds
    s_add_u32 m0, s57, 103424
    s_add_u32 s58, s55, 20480
    buffer_load_dwordx4 v18, s[44:47], s58 offen nt lds
    s_add_u32 m0, s57, 104448
    s_add_u32 s58, s55, 24576
    buffer_load_dwordx4 v19, s[44:47], s58 offen nt lds
    s_add_u32 m0, s57, 105472
    s_add_u32 s58, s55, 28672
    buffer_load_dwordx4 v19, s[44:47], s58 offen nt lds
    s_add_u32 m0, s57, 106496
    s_add_u32 s58, s55, 32768
    buffer_load_dwordx4 v16, s[44:47], s58 offen nt lds
    s_add_u32 m0, s57, 107520
    s_add_u32 s58, s55, 36864
    buffer_load_dwordx4 v16, s[44:47], s58 offen nt lds
    s_add_u32 m0, s57, 108544
    s_add_u32 s58, s55, 40960
    buffer_load_dwordx4 v17, s[44:47], s58 offen nt lds
    s_add_u32 m0, s57, 109568
    s_add_u32 s58, s55, 45056
    buffer_load_dwordx4 v17, s[44:47], s58 offen nt lds
    s_waitcnt vmcnt(11)
    s_add_u32 m0, s57, 110592
    s_add_u32 s58, s55, 49152
    buffer_load_dwordx4 v18, s[44:47], s58 offen nt lds
    s_waitcnt vmcnt(11)
    s_add_u32 m0, s57, 111616
    s_add_u32 s58, s55, 53248
    buffer_load_dwordx4 v18, s[44:47], s58 offen nt lds
    s_waitcnt vmcnt(11)
    s_add_u32 m0, s57, 112640
    s_add_u32 s58, s55, 57344
    buffer_load_dwordx4 v19, s[44:47], s58 offen nt lds
    s_waitcnt vmcnt(11)
    s_add_u32 m0, s57, 113664
    s_add_u32 s58, s55, 61440
    buffer_load_dwordx4 v19, s[44:47], s58 offen nt lds
    s_waitcnt vmcnt(0)
    ds_write_b32 v20, v22 offset:64
    s_waitcnt lgkmcnt(0)
    s_endpgm
L_final:
    s_lshr_b32 s60, s50, 0
    s_and_b32 s60, s60, 0xff
    s_lshr_b32 s61, s50, 8
    s_and_b32 s61, s61, 0xff
    s_lshr_b32 s62, s50, 16
    s_and_b32 s62, s62, 0xff
    s_lshr_b32 s63, s50, 24
    s_and_b32 s63, s63, 0xff
    s_mov_b32 s64, 0x07060500
    v_mov_b32 v8, s60
    v_mov_b32 v9, s61
    v_mov_b32 v10, s62
    v_mov_b32 v11, s63
    v_lshlrev_b32 v24, 2, v3
    v_add_u32 v24, 145232, v24
L_wf_35:
    ds_read_b32 v28, v21 offset:88
    ds_read_b32 v96, v24 offset:0
    ds_read_b32 v97, v24 offset:64
    ds_read_b32 v98, v24 offset:128
    ds_read_b32 v99, v24 offset:192
    s_sub_u32 s51, s51, 1
    s_cbranch_scc1 L_abort
    s_waitcnt lgkmcnt(0)
    v_cmp_ne_u32 vcc, 0, v28
    s_cbranch_vccz L_wf_35
    v_perm_b32 v4, v96, v8, s64
    v_perm_b32 v5, v97, v9, s64
    v_perm_b32 v6, v98, v10, s64
    v_perm_b32 v7, v99, v11, s64
    s_lshl_b32 s56, s2, 8
    s_add_u32 s56, s56, 196608
    v_lshlrev_b32 v24, 4, v0
    s_mov_b64 exec, 0xffff
    buffer_store_dwordx4 v[4:7], v24, s[28:31], s56 offen sc1
    s_mov_b64 exec, -1
    s_lshr_b32 s53, s49, 3
    s_lshl_b32 s53, s53, 3
    s_add_u32 s53, s53, s48
    s_and_b32 s54, s49, 7
    s_lshr_b32 s55, s53, 1
    s_lshl_b32 s55, s55, 6
    s_and_b32 s56, s53, 1
    s_lshl_b32 s56, s56, 3
    s_add_u32 s55, s55, s56
    s_add_u32 s55, s55, s54
    v_lshlrev_b32 v25, 5, v2
    s_lshl_b32 s55, s55, 1
    buffer_load_ushort v12, v25, s[32:35], s55 offen
    v_lshlrev_b32 v26, 2, v3
    v_add_u32 v26, v26, v2
    v_lshlrev_b32 v26, 8, v26
    s_lshr_b32 s56, s53, 1
    s_lshl_b32 s56, s56, 12
    s_and_b32 s57, s53, 1
    s_lshl_b32 s57, s57, 3
    s_add_u32 s57, s57, s54
    s_lshl_b32 s57, s57, 4
    s_add_u32 s57, s57, s56
    s_add_u32 s57, s57, 196608
    v_lshlrev_b32 v24, 7, v0
    s_lshl_b32 s56, s53, 13
    s_lshl_b32 s58, s54, 4
    s_add_u32 s56, s56, s58
    s_add_u32 s56, s56, 1048576
    s_mov_b32 s36, s24
    s_and_b32 s37, s25, 0xffff
    s_mov_b32 s38, 2048
    s_mov_b32 s39, 0x20000
L_wf_36:
    ds_read_b64 v[28:29], v21 offset:80
    s_sub_u32 s51, s51, 1
    s_cbranch_scc1 L_abort
    s_sleep 4
    s_waitcnt lgkmcnt(0)
    v_and_b32 v28, v28, v29
    v_cmp_ne_u32 vcc, 0, v28
    s_cbranch_vccz L_wf_36
    s_mov_b32 s70, 0xf000f
    s_mov_b32 s71, 0xf000f
    s_mov_b64 exec, s[70:71]
    buffer_load_dwordx4 v[32:35], v26, s[28:31], s57 offen sc1
    s_mov_b64 exec, -1
    s_branch L_me_38
L_mp_37:
    s_sub_u32 s51, s51, 1
    s_cbranch_scc1 L_abort
    s_mov_b64 exec, s[70:71]
    s_cbranch_execz L_sk_39
    buffer_load_dwordx4 v[32:35], v26, s[28:31], s57 offen sc1
L_sk_39:
    s_mov_b64 exec, -1
L_me_38:
    s_waitcnt vmcnt(0)
    s_mov_b64 s[66:67], 0
    s_mov_b64 exec, s[70:71]
    s_cbranch_execz L_sc_40
    v_xor_b32 v60, s60, v32
    v_bitop3_b32 v60, v60, v33, s61 bitop3:0xf6
    v_bitop3_b32 v60, v60, v34, s62 bitop3:0xf6
    v_bitop3_b32 v60, v60, v35, s63 bitop3:0xf6
    v_and_b32 v60, 0xff, v60
    v_cmp_ne_u32 vcc, 0, v60
    s_mov_b64 s[70:71], vcc
    s_or_b64 s[66:67], s[66:67], vcc
L_sc_40:
    s_mov_b64 exec, -1
    s_cmp_lg_u64 s[66:67], 0
    s_cbranch_scc1 L_mp_37
    v_permlane32_swap_b32 v32, v34
    v_permlane32_swap_b32 v33, v35
    v_add_f32 v32, v32, v34
    v_add_f32 v33, v33, v35
    s_nop 1
    v_permlane16_swap_b32 v32, v33
    v_add_f32 v32, v32, v33
    v_mov_b32 v96, v32
    s_nop 1
    v_add_f32_dpp v96, v96, v96 quad_perm:[1,0,3,2] row_mask:0xf bank_mask:0xf
    s_nop 1
    v_add_f32_dpp v96, v96, v96 quad_perm:[2,3,0,1] row_mask:0xf bank_mask:0xf
    v_cvt_pk_bf16_f32 v96, v96, v96
    v_lshlrev_b32 v96, 16, v96
    s_and_b32 s59, s59, 0xffff
    s_lshl_b32 s59, s59, 16
    v_add_f32 v96, s59, v96
    v_cvt_pk_bf16_f32 v96, v96, v96
    v_lshlrev_b32 v96, 16, v96
    v_mul_f32 v97, 0xbfb8aa3b, v96
    v_exp_f32 v97, v97
    s_nop 0
    v_add_f32 v97, 1.0, v97
    v_rcp_f32 v97, v97
    s_nop 0
    v_mul_f32 v96, v96, v97
    v_cvt_pk_bf16_f32 v96, v96, v96
    v_lshlrev_b32 v96, 16, v96
    v_lshlrev_b32 v14, 16, v12
L_wf_41:
    ds_read_b32 v28, v21 offset:108
    s_sub_u32 s51, s51, 1
    s_cbranch_scc1 L_abort
    s_sleep 1
    s_waitcnt lgkmcnt(0)
    v_cmp_ne_u32 vcc, 0, v28
    s_cbranch_vccz L_wf_41
    s_setprio 3
    s_sleep 18
    s_mov_b64 s[70:71], -1
    s_mov_b32 s69, 0
    buffer_load_dwordx4 v[28:31], v24, s[28:31], s56 offen sc1
    s_branch L_me_43
L_mp_42:
    s_sub_u32 s51, s51, 1
    s_cbranch_scc1 L_abort
    s_mov_b64 exec, s[70:71]
    s_cbranch_execz L_sk_44
    buffer_load_dwordx4 v[28:31], v24, s[28:31], s56 offen sc1
L_sk_44:
    s_mov_b64 exec, -1
L_me_43:
    s_add_u32 s69, s69, 1
    s_waitcnt vmcnt(0)
    s_mov_b64 s[66:67], 0
    s_mov_b64 exec, s[70:71]
    s_cbranch_execz L_sc_45
    v_xor_b32 v100, s60, v28
    v_bitop3_b32 v100, v100, v29, s61 bitop3:0xf6
    v_bitop3_b32 v100, v100, v30, s62 bitop3:0xf6
    v_bitop3_b32 v100, v100, v31, s63 bitop3:0xf6
    v_and_b32 v100, 0xff, v100
    v_cmp_ne_u32 vcc, 0, v100
    s_mov_b64 s[70:71], vcc
    s_or_b64 s[66:67], s[66:67], vcc
L_sc_45:
    s_mov_b64 exec, -1
    s_cmp_lg_u64 s[66:67], 0
    s_cbranch_scc1 L_mp_42
    v_permlane32_swap_b32 v28, v30
    v_permlane32_swap_b32 v29, v31
    v_add_f32 v28, v28, v30
    v_add_f32 v29, v29, v31
    s_nop 1
    v_permlane16_swap_b32 v28, v29
    v_add_f32 v28, v28, v29
    s_nop 1
    v_add_f32_dpp v28, v28, v28 row_ror:8 row_mask:0xf bank_mask:0xf
    s_nop 1
    v_add_f32_dpp v28, v28, v28 row_ror:4 row_mask:0xf bank_mask:0xf
    s_nop 1
    v_add_f32_dpp v28, v28, v28 row_ror:2 row_mask:0xf bank_mask:0xf
    s_nop 1
    v_add_f32_dpp v28, v28, v28 row_ror:1 row_mask:0xf bank_mask:0xf
    v_cvt_pk_bf16_f32 v28, v28, v28
    v_lshlrev_b32 v28, 16, v28
    v_mul_f32 v28, v28, v96
    v_cvt_pk_bf16_f32 v28, v28, v28
    v_lshlrev_b32 v28, 16, v28
    v_add_f32 v28, v28, v14
    v_cvt_pk_bf16_f32 v28, v28, v28
    s_mov_b32 exec_lo, 0x00010001
    s_mov_b32 exec_hi, 0x00010001
    buffer_store_short v28, v25, s[36:39], s55 offen
    s_cmp_lg_u32 s2, 0
    s_cbranch_scc1 L_ne_46
    s_mov_b64 exec, 1
    s_mul_i32 s57, s50, 0xe8b2f51
    v_mov_b32 v20, s57
    v_mov_b32 v23, 0
    buffer_store_dword v20, v23, s[28:31], 0 offen sc1
L_ne_46:
    s_mov_b64 exec, -1
    s_endpgm
    .p2align 12
L_bbranch:
    s_setprio 1
    v_mov_b32 v23, 145216
    v_mov_b32 v92, 0xc0135761
    v_mov_b32 v93, 0xbdd2d3e8
L_wf_47:
    ds_read_b32 v28, v21 offset:96
    ds_read_b128 v[32:35], v23
    ds_read_b32 v29, v21 offset:100
    s_sub_u32 s51, s51, 1
    s_cbranch_scc1 L_abort
    s_sleep 2
    s_waitcnt lgkmcnt(0)
    v_cmp_ne_u32 vcc, 0, v28
    s_cbranch_vccz L_wf_47
    v_readfirstlane_b32 s50, v29
    s_waitcnt vmcnt(0)
    v_lshlrev_b32 v40, 16, v40
    v_lshlrev_b32 v41, 16, v41
    v_lshlrev_b32 v42, 16, v42
    v_lshlrev_b32 v43, 16, v43
    v_lshlrev_b32 v44, 16, v44
    v_lshlrev_b32 v45, 16, v45
    v_lshlrev_b32 v46, 16, v46
    v_lshlrev_b32 v47, 16, v47
    v_lshlrev_b32 v48, 16, v48
    v_lshlrev_b32 v50, 16, v50
    v_lshlrev_b32 v52, 16, v52
    v_lshlrev_b32 v54, 16, v54
    v_cmp_gt_u32 vcc, 32, v0
    v_mov_b32 v94, 1.0
    v_mov_b32 v95, 1.0
    v_cndmask_b32 v54, 0, v54, vcc
    v_lshlrev_b32 v14, 16, v12
    v_sub_f32 v16, v14, v32
    v_cvt_pk_bf16_f32 v16, v16, v16
    v_lshlrev_b32 v16, 16, v16
    v_mul_f32 v16, v16, v33
    v_cvt_pk_bf16_f32 v16, v16, v16
    v_lshlrev_b32 v16, 16, v16
    v_sub_f32 v16, v16, v34
    v_cvt_pk_bf16_f32 v16, v16, v16
    v_lshlrev_b32 v16, 16, v16
    v_mul_f32 v16, v16, v35
    v_cvt_pk_bf16_f32 v16, v16, v16
    v_lshlrev_b32 v16, 16, v16
    s_nop 0
    v_readlane_b32 s64, v16, 0
    v_readlane_b32 s65, v16, 1
    v_readlane_b32 s66, v16, 2
    v_readlane_b32 s67, v16, 3
    v_readlane_b32 s68, v16, 4
    v_readlane_b32 s69, v16, 5
    v_readlane_b32 s70, v16, 6
    v_readlane_b32 s71, v16, 7
    v_readlane_b32 s72, v16, 8
    v_readlane_b32 s73, v16, 9
    v_readlane_b32 s74, v16, 10
    v_readlane_b32 s75, v16, 11
    v_readlane_b32 s76, v16, 12
    v_readlane_b32 s77, v16, 13
    v_readlane_b32 s78, v16, 14
    v_readlane_b32 s79, v16, 15
    s_nop 1
    v_pk_fma_f32 v[100:101], s[64:65], v[40:41], v[40:41] op_sel:[0,0,1] op_sel_hi:[1,0,1]
    v_pk_fma_f32 v[106:107], s[66:67], v[40:41], v[40:41] op_sel:[0,0,1] op_sel_hi:[1,0,1]
    v_pk_mul_f32 v[102:103], v[100:101], v[100:101]
    v_pk_mul_f32 v[108:109], v[106:107], v[106:107]
    v_pk_fma_f32 v[102:103], v[102:103], v[92:93], v[92:93] op_sel:[0,1,0] op_sel_hi:[1,1,0]
    v_pk_fma_f32 v[108:109], v[108:109], v[92:93], v[92:93] op_sel:[0,1,0] op_sel_hi:[1,1,0]
    v_pk_mul_f32 v[102:103], v[102:103], v[100:101]
    v_pk_mul_f32 v[108:109], v[108:109], v[106:107]
    v_pk_mul_f32 v[104:105], v[100:101], v[48:49] op_sel_hi:[1,0]
    v_pk_mul_f32 v[110:111], v[106:107], v[48:49] op_sel_hi:[1,0]
    v_exp_f32 v102, v102
    v_exp_f32 v103, v103
    v_exp_f32 v108, v108
    v_exp_f32 v109, v109
    s_nop 0
    v_pk_add_f32 v[102:103], v[102:103], v[94:95]
    v_pk_add_f32 v[108:109], v[108:109], v[94:95]
    v_rcp_f32 v102, v102
    v_rcp_f32 v103, v103
    v_rcp_f32 v108, v108
    v_rcp_f32 v109, v109
    s_nop 0
    v_pk_mul_f32 v[128:129], v[104:105], v[102:103]
    v_pk_mul_f32 v[130:131], v[110:111], v[108:109]
    v_pk_fma_f32 v[100:101], s[64:65], v[42:43], v[42:43] op_sel:[0,0,1] op_sel_hi:[1,0,1]
    v_pk_fma_f32 v[106:107], s[66:67], v[42:43], v[42:43] op_sel:[0,0,1] op_sel_hi:[1,0,1]
    v_pk_mul_f32 v[102:103], v[100:101], v[100:101]
    v_pk_mul_f32 v[108:109], v[106:107], v[106:107]
    v_pk_fma_f32 v[102:103], v[102:103], v[92:93], v[92:93] op_sel:[0,1,0] op_sel_hi:[1,1,0]
    v_pk_fma_f32 v[108:109], v[108:109], v[92:93], v[92:93] op_sel:[0,1,0] op_sel_hi:[1,1,0]
    v_pk_mul_f32 v[102:103], v[102:103], v[100:101]
    v_pk_mul_f32 v[108:109], v[108:109], v[106:107]
    v_pk_mul_f32 v[104:105], v[100:101], v[50:51] op_sel_hi:[1,0]
    v_pk_mul_f32 v[110:111], v[106:107], v[50:51] op_sel_hi:[1,0]
    v_exp_f32 v102, v102
    v_exp_f32 v103, v103
    v_exp_f32 v108, v108
    v_exp_f32 v109, v109
    s_nop 0
    v_pk_add_f32 v[102:103], v[102:103], v[94:95]
    v_pk_add_f32 v[108:109], v[108:109], v[94:95]
    v_rcp_f32 v102, v102
    v_rcp_f32 v103, v103
    v_rcp_f32 v108, v108
    v_rcp_f32 v109, v109
    s_nop 0
    v_pk_fma_f32 v[128:129], v[104:105], v[102:103], v[128:129]
    v_pk_fma_f32 v[130:131], v[110:111], v[108:109], v[130:131]
    v_pk_fma_f32 v[100:101], s[64:65], v[44:45], v[44:45] op_sel:[0,0,1] op_sel_hi:[1,0,1]
    v_pk_fma_f32 v[106:107], s[66:67], v[44:45], v[44:45] op_sel:[0,0,1] op_sel_hi:[1,0,1]
    v_pk_mul_f32 v[102:103], v[100:101], v[100:101]
    v_pk_mul_f32 v[108:109], v[106:107], v[106:107]
    v_pk_fma_f32 v[102:103], v[102:103], v[92:93], v[92:93] op_sel:[0,1,0] op_sel_hi:[1,1,0]
    v_pk_fma_f32 v[108:109], v[108:109], v[92:93], v[92:93] op_sel:[0,1,0] op_sel_hi:[1,1,0]
    v_pk_mul_f32 v[102:103], v[102:103], v[100:101]
    v_pk_mul_f32 v[108:109], v[108:109], v[106:107]
    v_pk_mul_f32 v[104:105], v[100:101], v[52:53] op_sel_hi:[1,0]
    v_pk_mul_f32 v[110:111], v[106:107], v[52:53] op_sel_hi:[1,0]
    v_exp_f32 v102, v102
    v_exp_f32 v103, v103
    v_exp_f32 v108, v108
    v_exp_f32 v109, v109
    s_nop 0
    v_pk_add_f32 v[102:103], v[102:103], v[94:95]
    v_pk_add_f32 v[108:109], v[108:109], v[94:95]
    v_rcp_f32 v102, v102
    v_rcp_f32 v103, v103
    v_rcp_f32 v108, v108
    v_rcp_f32 v109, v109
    s_nop 0
    v_pk_fma_f32 v[128:129], v[104:105], v[102:103], v[128:129]
    v_pk_fma_f32 v[130:131], v[110:111], v[108:109], v[130:131]
    v_pk_fma_f32 v[100:101], s[64:65], v[46:47], v[46:47] op_sel:[0,0,1] op_sel_hi:[1,0,1]
    v_pk_fma_f32 v[106:107], s[66:67], v[46:47], v[46:47] op_sel:[0,0,1] op_sel_hi:[1,0,1]
    v_pk_mul_f32 v[102:103], v[100:101], v[100:101]
    v_pk_mul_f32 v[108:109], v[106:107], v[106:107]
    v_pk_fma_f32 v[102:103], v[102:103], v[92:93], v[92:93] op_sel:[0,1,0] op_sel_hi:[1,1,0]
    v_pk_fma_f32 v[108:109], v[108:109], v[92:93], v[92:93] op_sel:[0,1,0] op_sel_hi:[1,1,0]
    v_pk_mul_f32 v[102:103], v[102:103], v[100:101]
    v_pk_mul_f32 v[108:109], v[108:109], v[106:107]
    v_pk_mul_f32 v[104:105], v[100:101], v[54:55] op_sel_hi:[1,0]
    v_pk_mul_f32 v[110:111], v[106:107], v[54:55] op_sel_hi:[1,0]
    v_exp_f32 v102, v102
    v_exp_f32 v103, v103
    v_exp_f32 v108, v108
    v_exp_f32 v109, v109
    s_nop 0
    v_pk_add_f32 v[102:103], v[102:103], v[94:95]
    v_pk_add_f32 v[108:109], v[108:109], v[94:95]
    v_rcp_f32 v102, v102
    v_rcp_f32 v103, v103
    v_rcp_f32 v108, v108
    v_rcp_f32 v109, v109
    s_nop 0
    v_pk_fma_f32 v[128:129], v[104:105], v[102:103], v[128:129]
    v_pk_fma_f32 v[130:131], v[110:111], v[108:109], v[130:131]
    v_pk_fma_f32 v[100:101], s[68:69], v[40:41], v[40:41] op_sel:[0,0,1] op_sel_hi:[1,0,1]
    v_pk_fma_f32 v[106:107], s[70:71], v[40:41], v[40:41] op_sel:[0,0,1] op_sel_hi:[1,0,1]
    v_pk_mul_f32 v[102:103], v[100:101], v[100:101]
    v_pk_mul_f32 v[108:109], v[106:107], v[106:107]
    v_pk_fma_f32 v[102:103], v[102:103], v[92:93], v[92:93] op_sel:[0,1,0] op_sel_hi:[1,1,0]
    v_pk_fma_f32 v[108:109], v[108:109], v[92:93], v[92:93] op_sel:[0,1,0] op_sel_hi:[1,1,0]
    v_pk_mul_f32 v[102:103], v[102:103], v[100:101]
    v_pk_mul_f32 v[108:109], v[108:109], v[106:107]
    v_pk_mul_f32 v[104:105], v[100:101], v[48:49] op_sel_hi:[1,0]
    v_pk_mul_f32 v[110:111], v[106:107], v[48:49] op_sel_hi:[1,0]
    v_exp_f32 v102, v102
    v_exp_f32 v103, v103
    v_exp_f32 v108, v108
    v_exp_f32 v109, v109
    s_nop 0
    v_pk_add_f32 v[102:103], v[102:103], v[94:95]
    v_pk_add_f32 v[108:109], v[108:109], v[94:95]
    v_rcp_f32 v102, v102
    v_rcp_f32 v103, v103
    v_rcp_f32 v108, v108
    v_rcp_f32 v109, v109
    s_nop 0
    v_pk_mul_f32 v[132:133], v[104:105], v[102:103]
    v_pk_mul_f32 v[134:135], v[110:111], v[108:109]
    v_pk_fma_f32 v[100:101], s[68:69], v[42:43], v[42:43] op_sel:[0,0,1] op_sel_hi:[1,0,1]
    v_pk_fma_f32 v[106:107], s[70:71], v[42:43], v[42:43] op_sel:[0,0,1] op_sel_hi:[1,0,1]
    v_pk_mul_f32 v[102:103], v[100:101], v[100:101]
    v_pk_mul_f32 v[108:109], v[106:107], v[106:107]
    v_pk_fma_f32 v[102:103], v[102:103], v[92:93], v[92:93] op_sel:[0,1,0] op_sel_hi:[1,1,0]
    v_pk_fma_f32 v[108:109], v[108:109], v[92:93], v[92:93] op_sel:[0,1,0] op_sel_hi:[1,1,0]
    v_pk_mul_f32 v[102:103], v[102:103], v[100:101]
    v_pk_mul_f32 v[108:109], v[108:109], v[106:107]
    v_pk_mul_f32 v[104:105], v[100:101], v[50:51] op_sel_hi:[1,0]
    v_pk_mul_f32 v[110:111], v[106:107], v[50:51] op_sel_hi:[1,0]
    v_exp_f32 v102, v102
    v_exp_f32 v103, v103
    v_exp_f32 v108, v108
    v_exp_f32 v109, v109
    s_nop 0
    v_pk_add_f32 v[102:103], v[102:103], v[94:95]
    v_pk_add_f32 v[108:109], v[108:109], v[94:95]
    v_rcp_f32 v102, v102
    v_rcp_f32 v103, v103
    v_rcp_f32 v108, v108
    v_rcp_f32 v109, v109
    s_nop 0
    v_pk_fma_f32 v[132:133], v[104:105], v[102:103], v[132:133]
    v_pk_fma_f32 v[134:135], v[110:111], v[108:109], v[134:135]
    v_pk_fma_f32 v[100:101], s[68:69], v[44:45], v[44:45] op_sel:[0,0,1] op_sel_hi:[1,0,1]
    v_pk_fma_f32 v[106:107], s[70:71], v[44:45], v[44:45] op_sel:[0,0,1] op_sel_hi:[1,0,1]
    v_pk_mul_f32 v[102:103], v[100:101], v[100:101]
    v_pk_mul_f32 v[108:109], v[106:107], v[106:107]
    v_pk_fma_f32 v[102:103], v[102:103], v[92:93], v[92:93] op_sel:[0,1,0] op_sel_hi:[1,1,0]
    v_pk_fma_f32 v[108:109], v[108:109], v[92:93], v[92:93] op_sel:[0,1,0] op_sel_hi:[1,1,0]
    v_pk_mul_f32 v[102:103], v[102:103], v[100:101]
    v_pk_mul_f32 v[108:109], v[108:109], v[106:107]
    v_pk_mul_f32 v[104:105], v[100:101], v[52:53] op_sel_hi:[1,0]
    v_pk_mul_f32 v[110:111], v[106:107], v[52:53] op_sel_hi:[1,0]
    v_exp_f32 v102, v102
    v_exp_f32 v103, v103
    v_exp_f32 v108, v108
    v_exp_f32 v109, v109
    s_nop 0
    v_pk_add_f32 v[102:103], v[102:103], v[94:95]
    v_pk_add_f32 v[108:109], v[108:109], v[94:95]
    v_rcp_f32 v102, v102
    v_rcp_f32 v103, v103
    v_rcp_f32 v108, v108
    v_rcp_f32 v109, v109
    s_nop 0
    v_pk_fma_f32 v[132:133], v[104:105], v[102:103], v[132:133]
    v_pk_fma_f32 v[134:135], v[110:111], v[108:109], v[134:135]
    v_pk_fma_f32 v[100:101], s[68:69], v[46:47], v[46:47] op_sel:[0,0,1] op_sel_hi:[1,0,1]
    v_pk_fma_f32 v[106:107], s[70:71], v[46:47], v[46:47] op_sel:[0,0,1] op_sel_hi:[1,0,1]
    v_pk_mul_f32 v[102:103], v[100:101], v[100:101]
    v_pk_mul_f32 v[108:109], v[106:107], v[106:107]
    v_pk_fma_f32 v[102:103], v[102:103], v[92:93], v[92:93] op_sel:[0,1,0] op_sel_hi:[1,1,0]
    v_pk_fma_f32 v[108:109], v[108:109], v[92:93], v[92:93] op_sel:[0,1,0] op_sel_hi:[1,1,0]
    v_pk_mul_f32 v[102:103], v[102:103], v[100:101]
    v_pk_mul_f32 v[108:109], v[108:109], v[106:107]
    v_pk_mul_f32 v[104:105], v[100:101], v[54:55] op_sel_hi:[1,0]
    v_pk_mul_f32 v[110:111], v[106:107], v[54:55] op_sel_hi:[1,0]
    v_exp_f32 v102, v102
    v_exp_f32 v103, v103
    v_exp_f32 v108, v108
    v_exp_f32 v109, v109
    s_nop 0
    v_pk_add_f32 v[102:103], v[102:103], v[94:95]
    v_pk_add_f32 v[108:109], v[108:109], v[94:95]
    v_rcp_f32 v102, v102
    v_rcp_f32 v103, v103
    v_rcp_f32 v108, v108
    v_rcp_f32 v109, v109
    s_nop 0
    v_pk_fma_f32 v[132:133], v[104:105], v[102:103], v[132:133]
    v_pk_fma_f32 v[134:135], v[110:111], v[108:109], v[134:135]
    v_pk_fma_f32 v[100:101], s[72:73], v[40:41], v[40:41] op_sel:[0,0,1] op_sel_hi:[1,0,1]
    v_pk_fma_f32 v[106:107], s[74:75], v[40:41], v[40:41] op_sel:[0,0,1] op_sel_hi:[1,0,1]
    v_pk_mul_f32 v[102:103], v[100:101], v[100:101]
    v_pk_mul_f32 v[108:109], v[106:107], v[106:107]
    v_pk_fma_f32 v[102:103], v[102:103], v[92:93], v[92:93] op_sel:[0,1,0] op_sel_hi:[1,1,0]
    v_pk_fma_f32 v[108:109], v[108:109], v[92:93], v[92:93] op_sel:[0,1,0] op_sel_hi:[1,1,0]
    v_pk_mul_f32 v[102:103], v[102:103], v[100:101]
    v_pk_mul_f32 v[108:109], v[108:109], v[106:107]
    v_pk_mul_f32 v[104:105], v[100:101], v[48:49] op_sel_hi:[1,0]
    v_pk_mul_f32 v[110:111], v[106:107], v[48:49] op_sel_hi:[1,0]
    v_exp_f32 v102, v102
    v_exp_f32 v103, v103
    v_exp_f32 v108, v108
    v_exp_f32 v109, v109
    s_nop 0
    v_pk_add_f32 v[102:103], v[102:103], v[94:95]
    v_pk_add_f32 v[108:109], v[108:109], v[94:95]
    v_rcp_f32 v102, v102
    v_rcp_f32 v103, v103
    v_rcp_f32 v108, v108
    v_rcp_f32 v109, v109
    s_nop 0
    v_pk_mul_f32 v[136:137], v[104:105], v[102:103]
    v_pk_mul_f32 v[138:139], v[110:111], v[108:109]
    v_pk_fma_f32 v[100:101], s[72:73], v[42:43], v[42:43] op_sel:[0,0,1] op_sel_hi:[1,0,1]
    v_pk_fma_f32 v[106:107], s[74:75], v[42:43], v[42:43] op_sel:[0,0,1] op_sel_hi:[1,0,1]
    v_pk_mul_f32 v[102:103], v[100:101], v[100:101]
    v_pk_mul_f32 v[108:109], v[106:107], v[106:107]
    v_pk_fma_f32 v[102:103], v[102:103], v[92:93], v[92:93] op_sel:[0,1,0] op_sel_hi:[1,1,0]
    v_pk_fma_f32 v[108:109], v[108:109], v[92:93], v[92:93] op_sel:[0,1,0] op_sel_hi:[1,1,0]
    v_pk_mul_f32 v[102:103], v[102:103], v[100:101]
    v_pk_mul_f32 v[108:109], v[108:109], v[106:107]
    v_pk_mul_f32 v[104:105], v[100:101], v[50:51] op_sel_hi:[1,0]
    v_pk_mul_f32 v[110:111], v[106:107], v[50:51] op_sel_hi:[1,0]
    v_exp_f32 v102, v102
    v_exp_f32 v103, v103
    v_exp_f32 v108, v108
    v_exp_f32 v109, v109
    s_nop 0
    v_pk_add_f32 v[102:103], v[102:103], v[94:95]
    v_pk_add_f32 v[108:109], v[108:109], v[94:95]
    v_rcp_f32 v102, v102
    v_rcp_f32 v103, v103
    v_rcp_f32 v108, v108
    v_rcp_f32 v109, v109
    s_nop 0
    v_pk_fma_f32 v[136:137], v[104:105], v[102:103], v[136:137]
    v_pk_fma_f32 v[138:139], v[110:111], v[108:109], v[138:139]
    v_pk_fma_f32 v[100:101], s[72:73], v[44:45], v[44:45] op_sel:[0,0,1] op_sel_hi:[1,0,1]
    v_pk_fma_f32 v[106:107], s[74:75], v[44:45], v[44:45] op_sel:[0,0,1] op_sel_hi:[1,0,1]
    v_pk_mul_f32 v[102:103], v[100:101], v[100:101]
    v_pk_mul_f32 v[108:109], v[106:107], v[106:107]
    v_pk_fma_f32 v[102:103], v[102:103], v[92:93], v[92:93] op_sel:[0,1,0] op_sel_hi:[1,1,0]
    v_pk_fma_f32 v[108:109], v[108:109], v[92:93], v[92:93] op_sel:[0,1,0] op_sel_hi:[1,1,0]
    v_pk_mul_f32 v[102:103], v[102:103], v[100:101]
    v_pk_mul_f32 v[108:109], v[108:109], v[106:107]
    v_pk_mul_f32 v[104:105], v[100:101], v[52:53] op_sel_hi:[1,0]
    v_pk_mul_f32 v[110:111], v[106:107], v[52:53] op_sel_hi:[1,0]
    v_exp_f32 v102, v102
    v_exp_f32 v103, v103
    v_exp_f32 v108, v108
    v_exp_f32 v109, v109
    s_nop 0
    v_pk_add_f32 v[102:103], v[102:103], v[94:95]
    v_pk_add_f32 v[108:109], v[108:109], v[94:95]
    v_rcp_f32 v102, v102
    v_rcp_f32 v103, v103
    v_rcp_f32 v108, v108
    v_rcp_f32 v109, v109
    s_nop 0
    v_pk_fma_f32 v[136:137], v[104:105], v[102:103], v[136:137]
    v_pk_fma_f32 v[138:139], v[110:111], v[108:109], v[138:139]
    v_pk_fma_f32 v[100:101], s[72:73], v[46:47], v[46:47] op_sel:[0,0,1] op_sel_hi:[1,0,1]
    v_pk_fma_f32 v[106:107], s[74:75], v[46:47], v[46:47] op_sel:[0,0,1] op_sel_hi:[1,0,1]
    v_pk_mul_f32 v[102:103], v[100:101], v[100:101]
    v_pk_mul_f32 v[108:109], v[106:107], v[106:107]
    v_pk_fma_f32 v[102:103], v[102:103], v[92:93], v[92:93] op_sel:[0,1,0] op_sel_hi:[1,1,0]
    v_pk_fma_f32 v[108:109], v[108:109], v[92:93], v[92:93] op_sel:[0,1,0] op_sel_hi:[1,1,0]
    v_pk_mul_f32 v[102:103], v[102:103], v[100:101]
    v_pk_mul_f32 v[108:109], v[108:109], v[106:107]
    v_pk_mul_f32 v[104:105], v[100:101], v[54:55] op_sel_hi:[1,0]
    v_pk_mul_f32 v[110:111], v[106:107], v[54:55] op_sel_hi:[1,0]
    v_exp_f32 v102, v102
    v_exp_f32 v103, v103
    v_exp_f32 v108, v108
    v_exp_f32 v109, v109
    s_nop 0
    v_pk_add_f32 v[102:103], v[102:103], v[94:95]
    v_pk_add_f32 v[108:109], v[108:109], v[94:95]
    v_rcp_f32 v102, v102
    v_rcp_f32 v103, v103
    v_rcp_f32 v108, v108
    v_rcp_f32 v109, v109
    s_nop 0
    v_pk_fma_f32 v[136:137], v[104:105], v[102:103], v[136:137]
    v_pk_fma_f32 v[138:139], v[110:111], v[108:109], v[138:139]
    v_pk_fma_f32 v[100:101], s[76:77], v[40:41], v[40:41] op_sel:[0,0,1] op_sel_hi:[1,0,1]
    v_pk_fma_f32 v[106:107], s[78:79], v[40:41], v[40:41] op_sel:[0,0,1] op_sel_hi:[1,0,1]
    v_pk_mul_f32 v[102:103], v[100:101], v[100:101]
    v_pk_mul_f32 v[108:109], v[106:107], v[106:107]
    v_pk_fma_f32 v[102:103], v[102:103], v[92:93], v[92:93] op_sel:[0,1,0] op_sel_hi:[1,1,0]
    v_pk_fma_f32 v[108:109], v[108:109], v[92:93], v[92:93] op_sel:[0,1,0] op_sel_hi:[1,1,0]
    v_pk_mul_f32 v[102:103], v[102:103], v[100:101]
    v_pk_mul_f32 v[108:109], v[108:109], v[106:107]
    v_pk_mul_f32 v[104:105], v[100:101], v[48:49] op_sel_hi:[1,0]
    v_pk_mul_f32 v[110:111], v[106:107], v[48:49] op_sel_hi:[1,0]
    v_exp_f32 v102, v102
    v_exp_f32 v103, v103
    v_exp_f32 v108, v108
    v_exp_f32 v109, v109
    s_nop 0
    v_pk_add_f32 v[102:103], v[102:103], v[94:95]
    v_pk_add_f32 v[108:109], v[108:109], v[94:95]
    v_rcp_f32 v102, v102
    v_rcp_f32 v103, v103
    v_rcp_f32 v108, v108
    v_rcp_f32 v109, v109
    s_nop 0
    v_pk_mul_f32 v[140:141], v[104:105], v[102:103]
    v_pk_mul_f32 v[142:143], v[110:111], v[108:109]
    v_pk_fma_f32 v[100:101], s[76:77], v[42:43], v[42:43] op_sel:[0,0,1] op_sel_hi:[1,0,1]
    v_pk_fma_f32 v[106:107], s[78:79], v[42:43], v[42:43] op_sel:[0,0,1] op_sel_hi:[1,0,1]
    v_pk_mul_f32 v[102:103], v[100:101], v[100:101]
    v_pk_mul_f32 v[108:109], v[106:107], v[106:107]
    v_pk_fma_f32 v[102:103], v[102:103], v[92:93], v[92:93] op_sel:[0,1,0] op_sel_hi:[1,1,0]
    v_pk_fma_f32 v[108:109], v[108:109], v[92:93], v[92:93] op_sel:[0,1,0] op_sel_hi:[1,1,0]
    v_pk_mul_f32 v[102:103], v[102:103], v[100:101]
    v_pk_mul_f32 v[108:109], v[108:109], v[106:107]
    v_pk_mul_f32 v[104:105], v[100:101], v[50:51] op_sel_hi:[1,0]
    v_pk_mul_f32 v[110:111], v[106:107], v[50:51] op_sel_hi:[1,0]
    v_exp_f32 v102, v102
    v_exp_f32 v103, v103
    v_exp_f32 v108, v108
    v_exp_f32 v109, v109
    s_nop 0
    v_pk_add_f32 v[102:103], v[102:103], v[94:95]
    v_pk_add_f32 v[108:109], v[108:109], v[94:95]
    v_rcp_f32 v102, v102
    v_rcp_f32 v103, v103
    v_rcp_f32 v108, v108
    v_rcp_f32 v109, v109
    s_nop 0
    v_pk_fma_f32 v[140:141], v[104:105], v[102:103], v[140:141]
    v_pk_fma_f32 v[142:143], v[110:111], v[108:109], v[142:143]
    v_pk_fma_f32 v[100:101], s[76:77], v[44:45], v[44:45] op_sel:[0,0,1] op_sel_hi:[1,0,1]
    v_pk_fma_f32 v[106:107], s[78:79], v[44:45], v[44:45] op_sel:[0,0,1] op_sel_hi:[1,0,1]
    v_pk_mul_f32 v[102:103], v[100:101], v[100:101]
    v_pk_mul_f32 v[108:109], v[106:107], v[106:107]
    v_pk_fma_f32 v[102:103], v[102:103], v[92:93], v[92:93] op_sel:[0,1,0] op_sel_hi:[1,1,0]
    v_pk_fma_f32 v[108:109], v[108:109], v[92:93], v[92:93] op_sel:[0,1,0] op_sel_hi:[1,1,0]
    v_pk_mul_f32 v[102:103], v[102:103], v[100:101]
    v_pk_mul_f32 v[108:109], v[108:109], v[106:107]
    v_pk_mul_f32 v[104:105], v[100:101], v[52:53] op_sel_hi:[1,0]
    v_pk_mul_f32 v[110:111], v[106:107], v[52:53] op_sel_hi:[1,0]
    v_exp_f32 v102, v102
    v_exp_f32 v103, v103
    v_exp_f32 v108, v108
    v_exp_f32 v109, v109
    s_nop 0
    v_pk_add_f32 v[102:103], v[102:103], v[94:95]
    v_pk_add_f32 v[108:109], v[108:109], v[94:95]
    v_rcp_f32 v102, v102
    v_rcp_f32 v103, v103
    v_rcp_f32 v108, v108
    v_rcp_f32 v109, v109
    s_nop 0
    v_pk_fma_f32 v[140:141], v[104:105], v[102:103], v[140:141]
    v_pk_fma_f32 v[142:143], v[110:111], v[108:109], v[142:143]
    v_pk_fma_f32 v[100:101], s[76:77], v[46:47], v[46:47] op_sel:[0,0,1] op_sel_hi:[1,0,1]
    v_pk_fma_f32 v[106:107], s[78:79], v[46:47], v[46:47] op_sel:[0,0,1] op_sel_hi:[1,0,1]
    v_pk_mul_f32 v[102:103], v[100:101], v[100:101]
    v_pk_mul_f32 v[108:109], v[106:107], v[106:107]
    v_pk_fma_f32 v[102:103], v[102:103], v[92:93], v[92:93] op_sel:[0,1,0] op_sel_hi:[1,1,0]
    v_pk_fma_f32 v[108:109], v[108:109], v[92:93], v[92:93] op_sel:[0,1,0] op_sel_hi:[1,1,0]
    v_pk_mul_f32 v[102:103], v[102:103], v[100:101]
    v_pk_mul_f32 v[108:109], v[108:109], v[106:107]
    v_pk_mul_f32 v[104:105], v[100:101], v[54:55] op_sel_hi:[1,0]
    v_pk_mul_f32 v[110:111], v[106:107], v[54:55] op_sel_hi:[1,0]
    v_exp_f32 v102, v102
    v_exp_f32 v103, v103
    v_exp_f32 v108, v108
    v_exp_f32 v109, v109
    s_nop 0
    v_pk_add_f32 v[102:103], v[102:103], v[94:95]
    v_pk_add_f32 v[108:109], v[108:109], v[94:95]
    v_rcp_f32 v102, v102
    v_rcp_f32 v103, v103
    v_rcp_f32 v108, v108
    v_rcp_f32 v109, v109
    s_nop 0
    v_pk_fma_f32 v[140:141], v[104:105], v[102:103], v[140:141]
    v_pk_fma_f32 v[142:143], v[110:111], v[108:109], v[142:143]
    s_nop 0
    v_readlane_b32 s64, v16, 16
    v_readlane_b32 s65, v16, 17
    v_readlane_b32 s66, v16, 18
    v_readlane_b32 s67, v16, 19
    v_readlane_b32 s68, v16, 20
    v_readlane_b32 s69, v16, 21
    v_readlane_b32 s70, v16, 22
    v_readlane_b32 s71, v16, 23
    v_readlane_b32 s72, v16, 24
    v_readlane_b32 s73, v16, 25
    v_readlane_b32 s74, v16, 26
    v_readlane_b32 s75, v16, 27
    v_readlane_b32 s76, v16, 28
    v_readlane_b32 s77, v16, 29
    v_readlane_b32 s78, v16, 30
    v_readlane_b32 s79, v16, 31
    s_nop 1
    v_pk_fma_f32 v[100:101], s[64:65], v[40:41], v[40:41] op_sel:[0,0,1] op_sel_hi:[1,0,1]
    v_pk_fma_f32 v[106:107], s[66:67], v[40:41], v[40:41] op_sel:[0,0,1] op_sel_hi:[1,0,1]
    v_pk_mul_f32 v[102:103], v[100:101], v[100:101]
    v_pk_mul_f32 v[108:109], v[106:107], v[106:107]
    v_pk_fma_f32 v[102:103], v[102:103], v[92:93], v[92:93] op_sel:[0,1,0] op_sel_hi:[1,1,0]
    v_pk_fma_f32 v[108:109], v[108:109], v[92:93], v[92:93] op_sel:[0,1,0] op_sel_hi:[1,1,0]
    v_pk_mul_f32 v[102:103], v[102:103], v[100:101]
    v_pk_mul_f32 v[108:109], v[108:109], v[106:107]
    v_pk_mul_f32 v[104:105], v[100:101], v[48:49] op_sel_hi:[1,0]
    v_pk_mul_f32 v[110:111], v[106:107], v[48:49] op_sel_hi:[1,0]
    v_exp_f32 v102, v102
    v_exp_f32 v103, v103
    v_exp_f32 v108, v108
    v_exp_f32 v109, v109
    s_nop 0
    v_pk_add_f32 v[102:103], v[102:103], v[94:95]
    v_pk_add_f32 v[108:109], v[108:109], v[94:95]
    v_rcp_f32 v102, v102
    v_rcp_f32 v103, v103
    v_rcp_f32 v108, v108
    v_rcp_f32 v109, v109
    s_nop 0
    v_pk_mul_f32 v[144:145], v[104:105], v[102:103]
    v_pk_mul_f32 v[146:147], v[110:111], v[108:109]
    v_pk_fma_f32 v[100:101], s[64:65], v[42:43], v[42:43] op_sel:[0,0,1] op_sel_hi:[1,0,1]
    v_pk_fma_f32 v[106:107], s[66:67], v[42:43], v[42:43] op_sel:[0,0,1] op_sel_hi:[1,0,1]
    v_pk_mul_f32 v[102:103], v[100:101], v[100:101]
    v_pk_mul_f32 v[108:109], v[106:107], v[106:107]
    v_pk_fma_f32 v[102:103], v[102:103], v[92:93], v[92:93] op_sel:[0,1,0] op_sel_hi:[1,1,0]
    v_pk_fma_f32 v[108:109], v[108:109], v[92:93], v[92:93] op_sel:[0,1,0] op_sel_hi:[1,1,0]
    v_pk_mul_f32 v[102:103], v[102:103], v[100:101]
    v_pk_mul_f32 v[108:109], v[108:109], v[106:107]
    v_pk_mul_f32 v[104:105], v[100:101], v[50:51] op_sel_hi:[1,0]
    v_pk_mul_f32 v[110:111], v[106:107], v[50:51] op_sel_hi:[1,0]
    v_exp_f32 v102, v102
    v_exp_f32 v103, v103
    v_exp_f32 v108, v108
    v_exp_f32 v109, v109
    s_nop 0
    v_pk_add_f32 v[102:103], v[102:103], v[94:95]
    v_pk_add_f32 v[108:109], v[108:109], v[94:95]
    v_rcp_f32 v102, v102
    v_rcp_f32 v103, v103
    v_rcp_f32 v108, v108
    v_rcp_f32 v109, v109
    s_nop 0
    v_pk_fma_f32 v[144:145], v[104:105], v[102:103], v[144:145]
    v_pk_fma_f32 v[146:147], v[110:111], v[108:109], v[146:147]
    v_pk_fma_f32 v[100:101], s[64:65], v[44:45], v[44:45] op_sel:[0,0,1] op_sel_hi:[1,0,1]
    v_pk_fma_f32 v[106:107], s[66:67], v[44:45], v[44:45] op_sel:[0,0,1] op_sel_hi:[1,0,1]
    v_pk_mul_f32 v[102:103], v[100:101], v[100:101]
    v_pk_mul_f32 v[108:109], v[106:107], v[106:107]
    v_pk_fma_f32 v[102:103], v[102:103], v[92:93], v[92:93] op_sel:[0,1,0] op_sel_hi:[1,1,0]
    v_pk_fma_f32 v[108:109], v[108:109], v[92:93], v[92:93] op_sel:[0,1,0] op_sel_hi:[1,1,0]
    v_pk_mul_f32 v[102:103], v[102:103], v[100:101]
    v_pk_mul_f32 v[108:109], v[108:109], v[106:107]
    v_pk_mul_f32 v[104:105], v[100:101], v[52:53] op_sel_hi:[1,0]
    v_pk_mul_f32 v[110:111], v[106:107], v[52:53] op_sel_hi:[1,0]
    v_exp_f32 v102, v102
    v_exp_f32 v103, v103
    v_exp_f32 v108, v108
    v_exp_f32 v109, v109
    s_nop 0
    v_pk_add_f32 v[102:103], v[102:103], v[94:95]
    v_pk_add_f32 v[108:109], v[108:109], v[94:95]
    v_rcp_f32 v102, v102
    v_rcp_f32 v103, v103
    v_rcp_f32 v108, v108
    v_rcp_f32 v109, v109
    s_nop 0
    v_pk_fma_f32 v[144:145], v[104:105], v[102:103], v[144:145]
    v_pk_fma_f32 v[146:147], v[110:111], v[108:109], v[146:147]
    v_pk_fma_f32 v[100:101], s[64:65], v[46:47], v[46:47] op_sel:[0,0,1] op_sel_hi:[1,0,1]
    v_pk_fma_f32 v[106:107], s[66:67], v[46:47], v[46:47] op_sel:[0,0,1] op_sel_hi:[1,0,1]
    v_pk_mul_f32 v[102:103], v[100:101], v[100:101]
    v_pk_mul_f32 v[108:109], v[106:107], v[106:107]
    v_pk_fma_f32 v[102:103], v[102:103], v[92:93], v[92:93] op_sel:[0,1,0] op_sel_hi:[1,1,0]
    v_pk_fma_f32 v[108:109], v[108:109], v[92:93], v[92:93] op_sel:[0,1,0] op_sel_hi:[1,1,0]
    v_pk_mul_f32 v[102:103], v[102:103], v[100:101]
    v_pk_mul_f32 v[108:109], v[108:109], v[106:107]
    v_pk_mul_f32 v[104:105], v[100:101], v[54:55] op_sel_hi:[1,0]
    v_pk_mul_f32 v[110:111], v[106:107], v[54:55] op_sel_hi:[1,0]
    v_exp_f32 v102, v102
    v_exp_f32 v103, v103
    v_exp_f32 v108, v108
    v_exp_f32 v109, v109
    s_nop 0
    v_pk_add_f32 v[102:103], v[102:103], v[94:95]
    v_pk_add_f32 v[108:109], v[108:109], v[94:95]
    v_rcp_f32 v102, v102
    v_rcp_f32 v103, v103
    v_rcp_f32 v108, v108
    v_rcp_f32 v109, v109
    s_nop 0
    v_pk_fma_f32 v[144:145], v[104:105], v[102:103], v[144:145]
    v_pk_fma_f32 v[146:147], v[110:111], v[108:109], v[146:147]
    v_pk_fma_f32 v[100:101], s[68:69], v[40:41], v[40:41] op_sel:[0,0,1] op_sel_hi:[1,0,1]
    v_pk_fma_f32 v[106:107], s[70:71], v[40:41], v[40:41] op_sel:[0,0,1] op_sel_hi:[1,0,1]
    v_pk_mul_f32 v[102:103], v[100:101], v[100:101]
    v_pk_mul_f32 v[108:109], v[106:107], v[106:107]
    v_pk_fma_f32 v[102:103], v[102:103], v[92:93], v[92:93] op_sel:[0,1,0] op_sel_hi:[1,1,0]
    v_pk_fma_f32 v[108:109], v[108:109], v[92:93], v[92:93] op_sel:[0,1,0] op_sel_hi:[1,1,0]
    v_pk_mul_f32 v[102:103], v[102:103], v[100:101]
    v_pk_mul_f32 v[108:109], v[108:109], v[106:107]
    v_pk_mul_f32 v[104:105], v[100:101], v[48:49] op_sel_hi:[1,0]
    v_pk_mul_f32 v[110:111], v[106:107], v[48:49] op_sel_hi:[1,0]
    v_exp_f32 v102, v102
    v_exp_f32 v103, v103
    v_exp_f32 v108, v108
    v_exp_f32 v109, v109
    s_nop 0
    v_pk_add_f32 v[102:103], v[102:103], v[94:95]
    v_pk_add_f32 v[108:109], v[108:109], v[94:95]
    v_rcp_f32 v102, v102
    v_rcp_f32 v103, v103
    v_rcp_f32 v108, v108
    v_rcp_f32 v109, v109
    s_nop 0
    v_pk_mul_f32 v[148:149], v[104:105], v[102:103]
    v_pk_mul_f32 v[150:151], v[110:111], v[108:109]
    v_pk_fma_f32 v[100:101], s[68:69], v[42:43], v[42:43] op_sel:[0,0,1] op_sel_hi:[1,0,1]
    v_pk_fma_f32 v[106:107], s[70:71], v[42:43], v[42:43] op_sel:[0,0,1] op_sel_hi:[1,0,1]
    v_pk_mul_f32 v[102:103], v[100:101], v[100:101]
    v_pk_mul_f32 v[108:109], v[106:107], v[106:107]
    v_pk_fma_f32 v[102:103], v[102:103], v[92:93], v[92:93] op_sel:[0,1,0] op_sel_hi:[1,1,0]
    v_pk_fma_f32 v[108:109], v[108:109], v[92:93], v[92:93] op_sel:[0,1,0] op_sel_hi:[1,1,0]
    v_pk_mul_f32 v[102:103], v[102:103], v[100:101]
    v_pk_mul_f32 v[108:109], v[108:109], v[106:107]
    v_pk_mul_f32 v[104:105], v[100:101], v[50:51] op_sel_hi:[1,0]
    v_pk_mul_f32 v[110:111], v[106:107], v[50:51] op_sel_hi:[1,0]
    v_exp_f32 v102, v102
    v_exp_f32 v103, v103
    v_exp_f32 v108, v108
    v_exp_f32 v109, v109
    s_nop 0
    v_pk_add_f32 v[102:103], v[102:103], v[94:95]
    v_pk_add_f32 v[108:109], v[108:109], v[94:95]
    v_rcp_f32 v102, v102
    v_rcp_f32 v103, v103
    v_rcp_f32 v108, v108
    v_rcp_f32 v109, v109
    s_nop 0
    v_pk_fma_f32 v[148:149], v[104:105], v[102:103], v[148:149]
    v_pk_fma_f32 v[150:151], v[110:111], v[108:109], v[150:151]
    v_pk_fma_f32 v[100:101], s[68:69], v[44:45], v[44:45] op_sel:[0,0,1] op_sel_hi:[1,0,1]
    v_pk_fma_f32 v[106:107], s[70:71], v[44:45], v[44:45] op_sel:[0,0,1] op_sel_hi:[1,0,1]
    v_pk_mul_f32 v[102:103], v[100:101], v[100:101]
    v_pk_mul_f32 v[108:109], v[106:107], v[106:107]
    v_pk_fma_f32 v[102:103], v[102:103], v[92:93], v[92:93] op_sel:[0,1,0] op_sel_hi:[1,1,0]
    v_pk_fma_f32 v[108:109], v[108:109], v[92:93], v[92:93] op_sel:[0,1,0] op_sel_hi:[1,1,0]
    v_pk_mul_f32 v[102:103], v[102:103], v[100:101]
    v_pk_mul_f32 v[108:109], v[108:109], v[106:107]
    v_pk_mul_f32 v[104:105], v[100:101], v[52:53] op_sel_hi:[1,0]
    v_pk_mul_f32 v[110:111], v[106:107], v[52:53] op_sel_hi:[1,0]
    v_exp_f32 v102, v102
    v_exp_f32 v103, v103
    v_exp_f32 v108, v108
    v_exp_f32 v109, v109
    s_nop 0
    v_pk_add_f32 v[102:103], v[102:103], v[94:95]
    v_pk_add_f32 v[108:109], v[108:109], v[94:95]
    v_rcp_f32 v102, v102
    v_rcp_f32 v103, v103
    v_rcp_f32 v108, v108
    v_rcp_f32 v109, v109
    s_nop 0
    v_pk_fma_f32 v[148:149], v[104:105], v[102:103], v[148:149]
    v_pk_fma_f32 v[150:151], v[110:111], v[108:109], v[150:151]
    v_pk_fma_f32 v[100:101], s[68:69], v[46:47], v[46:47] op_sel:[0,0,1] op_sel_hi:[1,0,1]
    v_pk_fma_f32 v[106:107], s[70:71], v[46:47], v[46:47] op_sel:[0,0,1] op_sel_hi:[1,0,1]
    v_pk_mul_f32 v[102:103], v[100:101], v[100:101]
    v_pk_mul_f32 v[108:109], v[106:107], v[106:107]
    v_pk_fma_f32 v[102:103], v[102:103], v[92:93], v[92:93] op_sel:[0,1,0] op_sel_hi:[1,1,0]
    v_pk_fma_f32 v[108:109], v[108:109], v[92:93], v[92:93] op_sel:[0,1,0] op_sel_hi:[1,1,0]
    v_pk_mul_f32 v[102:103], v[102:103], v[100:101]
    v_pk_mul_f32 v[108:109], v[108:109], v[106:107]
    v_pk_mul_f32 v[104:105], v[100:101], v[54:55] op_sel_hi:[1,0]
    v_pk_mul_f32 v[110:111], v[106:107], v[54:55] op_sel_hi:[1,0]
    v_exp_f32 v102, v102
    v_exp_f32 v103, v103
    v_exp_f32 v108, v108
    v_exp_f32 v109, v109
    s_nop 0
    v_pk_add_f32 v[102:103], v[102:103], v[94:95]
    v_pk_add_f32 v[108:109], v[108:109], v[94:95]
    v_rcp_f32 v102, v102
    v_rcp_f32 v103, v103
    v_rcp_f32 v108, v108
    v_rcp_f32 v109, v109
    s_nop 0
    v_pk_fma_f32 v[148:149], v[104:105], v[102:103], v[148:149]
    v_pk_fma_f32 v[150:151], v[110:111], v[108:109], v[150:151]
    v_pk_fma_f32 v[100:101], s[72:73], v[40:41], v[40:41] op_sel:[0,0,1] op_sel_hi:[1,0,1]
    v_pk_fma_f32 v[106:107], s[74:75], v[40:41], v[40:41] op_sel:[0,0,1] op_sel_hi:[1,0,1]
    v_pk_mul_f32 v[102:103], v[100:101], v[100:101]
    v_pk_mul_f32 v[108:109], v[106:107], v[106:107]
    v_pk_fma_f32 v[102:103], v[102:103], v[92:93], v[92:93] op_sel:[0,1,0] op_sel_hi:[1,1,0]
    v_pk_fma_f32 v[108:109], v[108:109], v[92:93], v[92:93] op_sel:[0,1,0] op_sel_hi:[1,1,0]
    v_pk_mul_f32 v[102:103], v[102:103], v[100:101]
    v_pk_mul_f32 v[108:109], v[108:109], v[106:107]
    v_pk_mul_f32 v[104:105], v[100:101], v[48:49] op_sel_hi:[1,0]
    v_pk_mul_f32 v[110:111], v[106:107], v[48:49] op_sel_hi:[1,0]
    v_exp_f32 v102, v102
    v_exp_f32 v103, v103
    v_exp_f32 v108, v108
    v_exp_f32 v109, v109
    s_nop 0
    v_pk_add_f32 v[102:103], v[102:103], v[94:95]
    v_pk_add_f32 v[108:109], v[108:109], v[94:95]
    v_rcp_f32 v102, v102
    v_rcp_f32 v103, v103
    v_rcp_f32 v108, v108
    v_rcp_f32 v109, v109
    s_nop 0
    v_pk_mul_f32 v[152:153], v[104:105], v[102:103]
    v_pk_mul_f32 v[154:155], v[110:111], v[108:109]
    v_pk_fma_f32 v[100:101], s[72:73], v[42:43], v[42:43] op_sel:[0,0,1] op_sel_hi:[1,0,1]
    v_pk_fma_f32 v[106:107], s[74:75], v[42:43], v[42:43] op_sel:[0,0,1] op_sel_hi:[1,0,1]
    v_pk_mul_f32 v[102:103], v[100:101], v[100:101]
    v_pk_mul_f32 v[108:109], v[106:107], v[106:107]
    v_pk_fma_f32 v[102:103], v[102:103], v[92:93], v[92:93] op_sel:[0,1,0] op_sel_hi:[1,1,0]
    v_pk_fma_f32 v[108:109], v[108:109], v[92:93], v[92:93] op_sel:[0,1,0] op_sel_hi:[1,1,0]
    v_pk_mul_f32 v[102:103], v[102:103], v[100:101]
    v_pk_mul_f32 v[108:109], v[108:109], v[106:107]
    v_pk_mul_f32 v[104:105], v[100:101], v[50:51] op_sel_hi:[1,0]
    v_pk_mul_f32 v[110:111], v[106:107], v[50:51] op_sel_hi:[1,0]
    v_exp_f32 v102, v102
    v_exp_f32 v103, v103
    v_exp_f32 v108, v108
    v_exp_f32 v109, v109
    s_nop 0
    v_pk_add_f32 v[102:103], v[102:103], v[94:95]
    v_pk_add_f32 v[108:109], v[108:109], v[94:95]
    v_rcp_f32 v102, v102
    v_rcp_f32 v103, v103
    v_rcp_f32 v108, v108
    v_rcp_f32 v109, v109
    s_nop 0
    v_pk_fma_f32 v[152:153], v[104:105], v[102:103], v[152:153]
    v_pk_fma_f32 v[154:155], v[110:111], v[108:109], v[154:155]
    v_pk_fma_f32 v[100:101], s[72:73], v[44:45], v[44:45] op_sel:[0,0,1] op_sel_hi:[1,0,1]
    v_pk_fma_f32 v[106:107], s[74:75], v[44:45], v[44:45] op_sel:[0,0,1] op_sel_hi:[1,0,1]
    v_pk_mul_f32 v[102:103], v[100:101], v[100:101]
    v_pk_mul_f32 v[108:109], v[106:107], v[106:107]
    v_pk_fma_f32 v[102:103], v[102:103], v[92:93], v[92:93] op_sel:[0,1,0] op_sel_hi:[1,1,0]
    v_pk_fma_f32 v[108:109], v[108:109], v[92:93], v[92:93] op_sel:[0,1,0] op_sel_hi:[1,1,0]
    v_pk_mul_f32 v[102:103], v[102:103], v[100:101]
    v_pk_mul_f32 v[108:109], v[108:109], v[106:107]
    v_pk_mul_f32 v[104:105], v[100:101], v[52:53] op_sel_hi:[1,0]
    v_pk_mul_f32 v[110:111], v[106:107], v[52:53] op_sel_hi:[1,0]
    v_exp_f32 v102, v102
    v_exp_f32 v103, v103
    v_exp_f32 v108, v108
    v_exp_f32 v109, v109
    s_nop 0
    v_pk_add_f32 v[102:103], v[102:103], v[94:95]
    v_pk_add_f32 v[108:109], v[108:109], v[94:95]
    v_rcp_f32 v102, v102
    v_rcp_f32 v103, v103
    v_rcp_f32 v108, v108
    v_rcp_f32 v109, v109
    s_nop 0
    v_pk_fma_f32 v[152:153], v[104:105], v[102:103], v[152:153]
    v_pk_fma_f32 v[154:155], v[110:111], v[108:109], v[154:155]
    v_pk_fma_f32 v[100:101], s[72:73], v[46:47], v[46:47] op_sel:[0,0,1] op_sel_hi:[1,0,1]
    v_pk_fma_f32 v[106:107], s[74:75], v[46:47], v[46:47] op_sel:[0,0,1] op_sel_hi:[1,0,1]
    v_pk_mul_f32 v[102:103], v[100:101], v[100:101]
    v_pk_mul_f32 v[108:109], v[106:107], v[106:107]
    v_pk_fma_f32 v[102:103], v[102:103], v[92:93], v[92:93] op_sel:[0,1,0] op_sel_hi:[1,1,0]
    v_pk_fma_f32 v[108:109], v[108:109], v[92:93], v[92:93] op_sel:[0,1,0] op_sel_hi:[1,1,0]
    v_pk_mul_f32 v[102:103], v[102:103], v[100:101]
    v_pk_mul_f32 v[108:109], v[108:109], v[106:107]
    v_pk_mul_f32 v[104:105], v[100:101], v[54:55] op_sel_hi:[1,0]
    v_pk_mul_f32 v[110:111], v[106:107], v[54:55] op_sel_hi:[1,0]
    v_exp_f32 v102, v102
    v_exp_f32 v103, v103
    v_exp_f32 v108, v108
    v_exp_f32 v109, v109
    s_nop 0
    v_pk_add_f32 v[102:103], v[102:103], v[94:95]
    v_pk_add_f32 v[108:109], v[108:109], v[94:95]
    v_rcp_f32 v102, v102
    v_rcp_f32 v103, v103
    v_rcp_f32 v108, v108
    v_rcp_f32 v109, v109
    s_nop 0
    v_pk_fma_f32 v[152:153], v[104:105], v[102:103], v[152:153]
    v_pk_fma_f32 v[154:155], v[110:111], v[108:109], v[154:155]
    v_pk_fma_f32 v[100:101], s[76:77], v[40:41], v[40:41] op_sel:[0,0,1] op_sel_hi:[1,0,1]
    v_pk_fma_f32 v[106:107], s[78:79], v[40:41], v[40:41] op_sel:[0,0,1] op_sel_hi:[1,0,1]
    v_pk_mul_f32 v[102:103], v[100:101], v[100:101]
    v_pk_mul_f32 v[108:109], v[106:107], v[106:107]
    v_pk_fma_f32 v[102:103], v[102:103], v[92:93], v[92:93] op_sel:[0,1,0] op_sel_hi:[1,1,0]
    v_pk_fma_f32 v[108:109], v[108:109], v[92:93], v[92:93] op_sel:[0,1,0] op_sel_hi:[1,1,0]
    v_pk_mul_f32 v[102:103], v[102:103], v[100:101]
    v_pk_mul_f32 v[108:109], v[108:109], v[106:107]
    v_pk_mul_f32 v[104:105], v[100:101], v[48:49] op_sel_hi:[1,0]
    v_pk_mul_f32 v[110:111], v[106:107], v[48:49] op_sel_hi:[1,0]
    v_exp_f32 v102, v102
    v_exp_f32 v103, v103
    v_exp_f32 v108, v108
    v_exp_f32 v109, v109
    s_nop 0
    v_pk_add_f32 v[102:103], v[102:103], v[94:95]
    v_pk_add_f32 v[108:109], v[108:109], v[94:95]
    v_rcp_f32 v102, v102
    v_rcp_f32 v103, v103
    v_rcp_f32 v108, v108
    v_rcp_f32 v109, v109
    s_nop 0
    v_pk_mul_f32 v[156:157], v[104:105], v[102:103]
    v_pk_mul_f32 v[158:159], v[110:111], v[108:109]
    v_pk_fma_f32 v[100:101], s[76:77], v[42:43], v[42:43] op_sel:[0,0,1] op_sel_hi:[1,0,1]
    v_pk_fma_f32 v[106:107], s[78:79], v[42:43], v[42:43] op_sel:[0,0,1] op_sel_hi:[1,0,1]
    v_pk_mul_f32 v[102:103], v[100:101], v[100:101]
    v_pk_mul_f32 v[108:109], v[106:107], v[106:107]
    v_pk_fma_f32 v[102:103], v[102:103], v[92:93], v[92:93] op_sel:[0,1,0] op_sel_hi:[1,1,0]
    v_pk_fma_f32 v[108:109], v[108:109], v[92:93], v[92:93] op_sel:[0,1,0] op_sel_hi:[1,1,0]
    v_pk_mul_f32 v[102:103], v[102:103], v[100:101]
    v_pk_mul_f32 v[108:109], v[108:109], v[106:107]
    v_pk_mul_f32 v[104:105], v[100:101], v[50:51] op_sel_hi:[1,0]
    v_pk_mul_f32 v[110:111], v[106:107], v[50:51] op_sel_hi:[1,0]
    v_exp_f32 v102, v102
    v_exp_f32 v103, v103
    v_exp_f32 v108, v108
    v_exp_f32 v109, v109
    s_nop 0
    v_pk_add_f32 v[102:103], v[102:103], v[94:95]
    v_pk_add_f32 v[108:109], v[108:109], v[94:95]
    v_rcp_f32 v102, v102
    v_rcp_f32 v103, v103
    v_rcp_f32 v108, v108
    v_rcp_f32 v109, v109
    s_nop 0
    v_pk_fma_f32 v[156:157], v[104:105], v[102:103], v[156:157]
    v_pk_fma_f32 v[158:159], v[110:111], v[108:109], v[158:159]
    v_pk_fma_f32 v[100:101], s[76:77], v[44:45], v[44:45] op_sel:[0,0,1] op_sel_hi:[1,0,1]
    v_pk_fma_f32 v[106:107], s[78:79], v[44:45], v[44:45] op_sel:[0,0,1] op_sel_hi:[1,0,1]
    v_pk_mul_f32 v[102:103], v[100:101], v[100:101]
    v_pk_mul_f32 v[108:109], v[106:107], v[106:107]
    v_pk_fma_f32 v[102:103], v[102:103], v[92:93], v[92:93] op_sel:[0,1,0] op_sel_hi:[1,1,0]
    v_pk_fma_f32 v[108:109], v[108:109], v[92:93], v[92:93] op_sel:[0,1,0] op_sel_hi:[1,1,0]
    v_pk_mul_f32 v[102:103], v[102:103], v[100:101]
    v_pk_mul_f32 v[108:109], v[108:109], v[106:107]
    v_pk_mul_f32 v[104:105], v[100:101], v[52:53] op_sel_hi:[1,0]
    v_pk_mul_f32 v[110:111], v[106:107], v[52:53] op_sel_hi:[1,0]
    v_exp_f32 v102, v102
    v_exp_f32 v103, v103
    v_exp_f32 v108, v108
    v_exp_f32 v109, v109
    s_nop 0
    v_pk_add_f32 v[102:103], v[102:103], v[94:95]
    v_pk_add_f32 v[108:109], v[108:109], v[94:95]
    v_rcp_f32 v102, v102
    v_rcp_f32 v103, v103
    v_rcp_f32 v108, v108
    v_rcp_f32 v109, v109
    s_nop 0
    v_pk_fma_f32 v[156:157], v[104:105], v[102:103], v[156:157]
    v_pk_fma_f32 v[158:159], v[110:111], v[108:109], v[158:159]
    v_pk_fma_f32 v[100:101], s[76:77], v[46:47], v[46:47] op_sel:[0,0,1] op_sel_hi:[1,0,1]
    v_pk_fma_f32 v[106:107], s[78:79], v[46:47], v[46:47] op_sel:[0,0,1] op_sel_hi:[1,0,1]
    v_pk_mul_f32 v[102:103], v[100:101], v[100:101]
    v_pk_mul_f32 v[108:109], v[106:107], v[106:107]
    v_pk_fma_f32 v[102:103], v[102:103], v[92:93], v[92:93] op_sel:[0,1,0] op_sel_hi:[1,1,0]
    v_pk_fma_f32 v[108:109], v[108:109], v[92:93], v[92:93] op_sel:[0,1,0] op_sel_hi:[1,1,0]
    v_pk_mul_f32 v[102:103], v[102:103], v[100:101]
    v_pk_mul_f32 v[108:109], v[108:109], v[106:107]
    v_pk_mul_f32 v[104:105], v[100:101], v[54:55] op_sel_hi:[1,0]
    v_pk_mul_f32 v[110:111], v[106:107], v[54:55] op_sel_hi:[1,0]
    v_exp_f32 v102, v102
    v_exp_f32 v103, v103
    v_exp_f32 v108, v108
    v_exp_f32 v109, v109
    s_nop 0
    v_pk_add_f32 v[102:103], v[102:103], v[94:95]
    v_pk_add_f32 v[108:109], v[108:109], v[94:95]
    v_rcp_f32 v102, v102
    v_rcp_f32 v103, v103
    v_rcp_f32 v108, v108
    v_rcp_f32 v109, v109
    s_nop 0
    v_pk_fma_f32 v[156:157], v[104:105], v[102:103], v[156:157]
    v_pk_fma_f32 v[158:159], v[110:111], v[108:109], v[158:159]
    s_nop 1
    v_permlane32_swap_b32 v128, v144
    v_permlane32_swap_b32 v129, v145
    v_permlane32_swap_b32 v130, v146
    v_permlane32_swap_b32 v131, v147
    v_permlane32_swap_b32 v132, v148
    v_permlane32_swap_b32 v133, v149
    v_permlane32_swap_b32 v134, v150
    v_permlane32_swap_b32 v135, v151
    v_permlane32_swap_b32 v136, v152
    v_permlane32_swap_b32 v137, v153
    v_permlane32_swap_b32 v138, v154
    v_permlane32_swap_b32 v139, v155
    v_permlane32_swap_b32 v140, v156
    v_permlane32_swap_b32 v141, v157
    v_permlane32_swap_b32 v142, v158
    v_permlane32_swap_b32 v143, v159
    v_add_f32 v128, v128, v144
    v_add_f32 v129, v129, v145
    v_add_f32 v130, v130, v146
    v_add_f32 v131, v131, v147
    v_add_f32 v132, v132, v148
    v_add_f32 v133, v133, v149
    v_add_f32 v134, v134, v150
    v_add_f32 v135, v135, v151
    v_add_f32 v136, v136, v152
    v_add_f32 v137, v137, v153
    v_add_f32 v138, v138, v154
    v_add_f32 v139, v139, v155
    v_add_f32 v140, v140, v156
    v_add_f32 v141, v141, v157
    v_add_f32 v142, v142, v158
    v_add_f32 v143, v143, v159
    s_nop 0
    v_permlane16_swap_b32 v128, v136
    v_permlane16_swap_b32 v129, v137
    v_permlane16_swap_b32 v130, v138
    v_permlane16_swap_b32 v131, v139
    v_permlane16_swap_b32 v132, v140
    v_permlane16_swap_b32 v133, v141
    v_permlane16_swap_b32 v134, v142
    v_permlane16_swap_b32 v135, v143
    v_add_f32 v128, v128, v136
    v_add_f32 v129, v129, v137
    v_add_f32 v130, v130, v138
    v_add_f32 v131, v131, v139
    v_add_f32 v132, v132, v140
    v_add_f32 v133, v133, v141
    v_add_f32 v134, v134, v142
    v_add_f32 v135, v135, v143
    s_nop 0
    v_add_f32_dpp v128, v128, v128 row_ror:8 row_mask:0xf bank_mask:0xf
    v_add_f32_dpp v129, v129, v129 row_ror:8 row_mask:0xf bank_mask:0xf
    v_add_f32_dpp v130, v130, v130 row_ror:8 row_mask:0xf bank_mask:0xf
    v_add_f32_dpp v131, v131, v131 row_ror:8 row_mask:0xf bank_mask:0xf
    v_add_f32_dpp v132, v132, v132 row_ror:8 row_mask:0xf bank_mask:0xf
    v_add_f32_dpp v133, v133, v133 row_ror:8 row_mask:0xf bank_mask:0xf
    v_add_f32_dpp v134, v134, v134 row_ror:8 row_mask:0xf bank_mask:0xf
    v_add_f32_dpp v135, v135, v135 row_ror:8 row_mask:0xf bank_mask:0xf
    s_nop 0
    v_add_f32_dpp v128, v128, v128 row_ror:4 row_mask:0xf bank_mask:0xf
    v_add_f32_dpp v129, v129, v129 row_ror:4 row_mask:0xf bank_mask:0xf
    v_add_f32_dpp v130, v130, v130 row_ror:4 row_mask:0xf bank_mask:0xf
    v_add_f32_dpp v131, v131, v131 row_ror:4 row_mask:0xf bank_mask:0xf
    v_add_f32_dpp v132, v132, v132 row_ror:4 row_mask:0xf bank_mask:0xf
    v_add_f32_dpp v133, v133, v133 row_ror:4 row_mask:0xf bank_mask:0xf
    v_add_f32_dpp v134, v134, v134 row_ror:4 row_mask:0xf bank_mask:0xf
    v_add_f32_dpp v135, v135, v135 row_ror:4 row_mask:0xf bank_mask:0xf
    s_nop 0
    v_add_f32_dpp v128, v128, v128 row_ror:2 row_mask:0xf bank_mask:0xf
    v_add_f32_dpp v129, v129, v129 row_ror:2 row_mask:0xf bank_mask:0xf
    v_add_f32_dpp v130, v130, v130 row_ror:2 row_mask:0xf bank_mask:0xf
    v_add_f32_dpp v131, v131, v131 row_ror:2 row_mask:0xf bank_mask:0xf
    v_add_f32_dpp v132, v132, v132 row_ror:2 row_mask:0xf bank_mask:0xf
    v_add_f32_dpp v133, v133, v133 row_ror:2 row_mask:0xf bank_mask:0xf
    v_add_f32_dpp v134, v134, v134 row_ror:2 row_mask:0xf bank_mask:0xf
    v_add_f32_dpp v135, v135, v135 row_ror:2 row_mask:0xf bank_mask:0xf
    s_nop 0
    v_add_f32_dpp v128, v128, v128 row_ror:1 row_mask:0xf bank_mask:0xf
    v_add_f32_dpp v129, v129, v129 row_ror:1 row_mask:0xf bank_mask:0xf
    v_add_f32_dpp v130, v130, v130 row_ror:1 row_mask:0xf bank_mask:0xf
    v_add_f32_dpp v131, v131, v131 row_ror:1 row_mask:0xf bank_mask:0xf
    v_add_f32_dpp v132, v132, v132 row_ror:1 row_mask:0xf bank_mask:0xf
    v_add_f32_dpp v133, v133, v133 row_ror:1 row_mask:0xf bank_mask:0xf
    v_add_f32_dpp v134, v134, v134 row_ror:1 row_mask:0xf bank_mask:0xf
    v_add_f32_dpp v135, v135, v135 row_ror:1 row_mask:0xf bank_mask:0xf
    s_lshl_b32 s57, s52, 7
    s_add_u32 s57, s57, 145232
    v_lshlrev_b32 v24, 5, v2
    v_add_u32 v24, s57, v24
    s_mov_b32 exec_lo, 0x00010001
    s_mov_b32 exec_hi, 0x00010001
    ds_write_b128 v24, v[128:131]
    ds_write_b128 v24, v[132:135] offset:16
    s_mov_b64 exec, -1
    s_cmp_eq_u32 s52, 0
    s_cbranch_scc1 L_final
    ds_write_b32 v21, v22 offset:88
    s_waitcnt lgkmcnt(0)
    s_endpgm
L_abort:
    s_endpgm
L_exit:
    s_endpgm
.section .rodata,"a"
.p2align 6
.amdhsa_kernel recurrent_scan__sliding_block_cached__mixer_token_mlp__decode_kernel
  .amdhsa_next_free_vgpr 224
  .amdhsa_next_free_sgpr 100
  .amdhsa_accum_offset 224
  .amdhsa_group_segment_fixed_size 0
  .amdhsa_kernarg_size 104
  .amdhsa_user_sgpr_count 2
  .amdhsa_user_sgpr_kernarg_segment_ptr 1
  .amdhsa_system_sgpr_workgroup_id_x 1
.end_amdhsa_kernel
```
